```python
import torch

def _softmax(x, axis=-1):
    return torch.softmax(x, dim=axis)
def _gelu(x):
    return torch.nn.functional.gelu(x, approximate="tanh")
def _silu(x):
    return torch.nn.functional.silu(x)
def _sigmoid(x):
    return torch.sigmoid(x)
def _layernorm(x, axis=-1, eps=1e-5):
    m = x.mean(dim=axis, keepdim=True)
    v = x.var(dim=axis, keepdim=True, unbiased=False)
    return (x - m) / torch.sqrt(v + eps)
def _scatter_add(tgt, idx, src, axis=0):
    return tgt.clone().index_add_(axis, idx, src)
def _segment_sum(src, seg, n):
    out = torch.zeros((n,) + src.shape[1:], dtype=src.dtype)
    return out.index_add_(0, seg, src)
def _pad(x, pw):
    flat = tuple(v for pair in reversed(pw) for v in pair)
    return torch.nn.functional.pad(x, flat)

kernel_name = 'gated_mix__grouped_kv_mqa__glu_gated_geglu__prompt'

def setup_inputs():

    _w = (lambda a: (lambda t: t.to(torch.bfloat16) if t.is_floating_point() else t)(torch.as_tensor(a)))
    def _A_setup():
        B, S, D, H = 1, 2048, 512, 32
        Dh = D // H
        return {
            "x": _w((lambda *s: torch.randn(*s, dtype=torch.bfloat16) * 0.05)(B, S, D)),
            "wq": _w((lambda *s: torch.randn(*s, dtype=torch.bfloat16) * 0.8)(D, H * Dh)),
            "wk": _w((lambda *s: torch.randn(*s, dtype=torch.bfloat16) * 0.8)(D, Dh)),
            "wv": _w((lambda *s: torch.randn(*s, dtype=torch.bfloat16) * 0.05)(D, Dh)),
            "wo": _w((lambda *s: torch.randn(*s, dtype=torch.bfloat16) * 0.05)(H * Dh, D)),
        }
    _A_in = _A_setup()

    def _B_setup():
        B, S, Dm, Df = 1, 2048, 512, 1376
        return {
            "x": _w((lambda *s: torch.randn(*s, dtype=torch.bfloat16) * 0.05)(B, S, Dm)),
            "w_gate": _w((lambda *s: torch.randn(*s, dtype=torch.bfloat16) * 0.8)(Dm, Df) * (Dm ** -0.5)),
            "w_up": _w((lambda *s: torch.randn(*s, dtype=torch.bfloat16) * 0.8)(Dm, Df) * (Dm ** -0.5)),
            "w_down": _w((lambda *s: torch.randn(*s, dtype=torch.bfloat16) * 0.8)(Df, Dm) * (Df ** -0.5)),
        }
    _B_in = _B_setup()

    return {
        "A_x": _A_in["x"],
        "A_wq": _A_in["wq"],
        "A_wk": _A_in["wk"],
        "A_wv": _A_in["wv"],
        "A_wo": _A_in["wo"],
        "B_x": _B_in["x"],
        "B_w_gate": _B_in["w_gate"],
        "B_w_up": _B_in["w_up"],
        "B_w_down": _B_in["w_down"],
        "gate_w": _w((lambda *s: torch.randn(*s, dtype=torch.bfloat16) * 0.05)(512) * 16.0),
    }

def reference(A_x, A_wq, A_wk, A_wv, A_wo, B_x, B_w_gate, B_w_up, B_w_down, gate_w):
    def _A_ref(x, wq, wk, wv, wo):
        B, S, D = x.shape
        H = 32
        Dh = D // H
        q = (lambda x, *d: x.permute(*d))((x @ wq).reshape(B, S, H, Dh), 0, 2, 1, 3)
        k = x @ wk
        v = x @ wv
        scores = torch.einsum("bhqd,bkd->bhqk", q, k) * (Dh ** -0.5)
        p = _softmax(scores, axis=-1)
        o = torch.einsum("bhqk,bkd->bhqd", p, v)
        return (lambda x, *d: x.permute(*d))(o, 0, 2, 1, 3).reshape(B, S, H * Dh) @ wo

    def _B_ref(x, w_gate, w_up, w_down):
        g = torch.einsum("bsd,df->bsf", x, w_gate)
        u = torch.einsum("bsd,df->bsf", x, w_up)
        h = _gelu(g) * u
        return torch.einsum("bsf,fd->bsd", h, w_down)

    x = A_x
    g = _sigmoid((x * gate_w).sum(-1, keepdims=True))
    a = _A_ref(x, A_wq, A_wk, A_wv, A_wo)
    b = _B_ref(x, B_w_gate, B_w_up, B_w_down)
    return g * a + (1 - g) * b
```

```asm
; @launch grid=(256,1,1) block=(512,1,1) lds=163840
.amdgcn_target "amdgcn-amd-amdhsa--gfx950"
.text
.globl gated_mix__grouped_kv_mqa__glu_gated_geglu__prompt_kernel
.p2align 8
.type gated_mix__grouped_kv_mqa__glu_gated_geglu__prompt_kernel,@function
gated_mix__grouped_kv_mqa__glu_gated_geglu__prompt_kernel:
    s_cmp_ge_u32 s2, 256
    s_cbranch_scc1 L_exit
    s_load_dwordx16 s[8:23], s[0:1], 0
    s_load_dwordx8 s[24:31], s[0:1], 64
    s_load_dwordx2 s[32:33], s[0:1], 96
    v_lshrrev_b32 v1, 6, v0
    s_getpc_b64 s[90:91]
L_pc0:
    s_and_b32 s3, s2, 0xf8
    v_add_u32 v2, s3, v1
    v_and_b32 v3, 1, v0
    v_lshl_add_u32 v2, v3, 8, v2
    v_lshlrev_b32 v2, 7, v2
    v_min_u32 v2, L_exit-L_pc0, v2
    global_load_dword v252, v2, s[90:91]
    v_and_b32 v0, 63, v0
    v_readfirstlane_b32 s3, v1
    s_and_b32 s5, s2, 1
    s_lshl_b32 s5, s5, 3
    s_bfe_u32 s79, s2, 0x30003
    s_add_u32 s5, s5, s79
    s_bfe_u32 s4, s2, 0x20001
    s_lshl_b32 s4, s4, 2
    s_lshr_b32 s80, s2, 6
    s_add_u32 s4, s4, s80
    s_lshl_b32 s80, s80, 1
    s_add_u32 s101, s79, s80
    s_and_b32 s101, s101, 7
    s_and_b32 s6, s3, 3
    s_lshl_b32 s7, s4, 2
    s_add_u32 s7, s7, s6
    s_lshl_b32 s78, s6, 15
    s_bfe_u32 s79, s5, 0x20001
    s_cmp_eq_u32 s79, s6
    s_cselect_b32 s100, 1, 0
    s_and_b32 s34, s5, 1
    v_lshlrev_b32 v4, 4, v0
    v_lshrrev_b32 v16, 3, v0
    v_and_b32 v17, 7, v0
    v_lshrrev_b32 v3, 4, v0
    v_xor_b32 v17, v17, v3
    v_lshlrev_b32 v17, 4, v17
    v_lshl_add_u32 v16, v16, 10, v17
    v_xor_b32 v17, 64, v16
    v_add_u32 v17, 7168, v17
    s_lshl_b32 s35, s7, 15
    s_cmp_lt_u32 s3, 4
    s_cbranch_scc1 L_A
    s_cmp_eq_u32 s100, 0
    s_cbranch_scc1 L_G_np
    s_mov_b32 s88, s101
    s_mov_b32 s89, 24576
    s_lshl_b32 s79, s34, 11
    s_add_u32 s90, s78, s79
    s_lshl_b32 s79, s34, 14
    s_add_u32 s35, s35, s79
    s_mov_b32 s87, 131072
    s_cmp_lt_u32 s5, 8
    s_waitcnt lgkmcnt(0)
    s_cselect_b32 s44, s12, s14
    s_cselect_b32 s45, s13, s15
    s_mov_b32 s46, 16384
    s_mov_b32 s47, 0x20000
    s_mov_b32 s36, s8
    s_mov_b32 s37, s9
    s_mov_b32 s38, 2097152
    s_mov_b32 s39, 0x20000
    s_load_dwordx2 s[76:77], s[32:33], 0
    s_mov_b32 s64, s26
    s_mov_b32 s65, s27
    s_mov_b32 s66, 1024
    s_mov_b32 s67, 0x20000
    s_lshl_b32 s79, s101, 7
    v_add_u32 v3, s79, v4
    v_and_b32 v3, 1023, v3
    s_mov_b32 m0, 160000
    s_nop 0
    buffer_load_dwordx4 v3, s[64:67], 0 offen lds
L_G_kvl:
    s_mov_b32 m0, s87
    s_lshl_b32 s81, s88, 11
    buffer_load_dwordx4 v4, s[44:47], s81 offen lds
    buffer_load_dwordx4 v4, s[44:47], s81 offen offset:1024 lds
    s_lshl_b32 s81, s88, 7
    s_add_u32 m0, s90, s89
    s_add_u32 s81, s81, s35
    buffer_load_dwordx4 v16, s[36:39], s81 offen lds
    buffer_load_dwordx4 v17, s[36:39], s81 offen offset:1024 lds
    s_add_u32 s88, s88, 1
    s_and_b32 s88, s88, 7
    s_add_u32 s89, s89, 4096
    s_and_b32 s89, s89, 0x7fff
    s_add_u32 s87, s87, 2048
    s_cmp_lt_u32 s87, 147456
    s_cbranch_scc1 L_G_kvl
    s_branch L_G_setup
L_G_np:
    s_waitcnt lgkmcnt(0)
    s_load_dwordx2 s[76:77], s[32:33], 0
L_G_setup:
    s_barrier
    s_mov_b32 s72, s32
    s_mov_b32 s73, s33
    s_mov_b32 s74, 8781824
    s_mov_b32 s75, 0x20000
    s_mov_b32 s83, 0x200000
    v_lshlrev_b32 v3, 2, v0
    v_add_u32 v1, 161152, v3
    v_mov_b32 v2, 161024
    s_mov_b64 exec, 1
    v_mov_b32 v1, v2
    s_mov_b64 exec, -1
    v_mov_b32 v2, 1
    s_lshl_b32 s79, s6, 2
    s_add_u32 s79, s79, 80
    v_add_u32 v5, s79, v1
    s_mov_b32 s52, s20
    s_mov_b32 s53, s21
    s_mov_b32 s54, 1409024
    s_mov_b32 s55, 0x20000
    s_mov_b32 s56, s22
    s_mov_b32 s57, s23
    s_mov_b32 s58, 1409024
    s_mov_b32 s59, 0x20000
    s_mov_b32 s60, s24
    s_mov_b32 s61, s25
    s_mov_b32 s62, 1409024
    s_mov_b32 s63, 0x20000
    s_mov_b32 s48, s16
    s_mov_b32 s49, s17
    s_mov_b32 s50, 524288
    s_mov_b32 s51, 0x20000
    s_mov_b32 s68, s28
    s_mov_b32 s69, s29
    s_mov_b32 s70, 2097152
    s_mov_b32 s71, 0x20000
    v_and_b32 v44, 31, v0
    v_lshrrev_b32 v47, 5, v0
    v_bfe_u32 v46, v0, 1, 3
    v_lshlrev_b32 v44, 7, v44
    v_add_u32 v44, s78, v44
    v_add_u32 v3, 0, v47
    v_xor_b32 v3, v3, v46
    v_lshl_add_u32 v34, v3, 4, v44
    v_add_u32 v3, 2, v47
    v_xor_b32 v3, v3, v46
    v_lshl_add_u32 v35, v3, 4, v44
    v_add_u32 v3, 4, v47
    v_xor_b32 v3, v3, v46
    v_lshl_add_u32 v36, v3, 4, v44
    v_add_u32 v3, 6, v47
    v_xor_b32 v3, v3, v46
    v_lshl_add_u32 v37, v3, 4, v44
    v_and_b32 v13, 31, v0
    v_lshlrev_b32 v13, 2, v13
    v_bfe_u32 v44, v0, 2, 2
    v_and_b32 v45, 3, v0
    v_lshlrev_b32 v45, 3, v45
    v_bfe_u32 v46, v0, 4, 1
    v_lshrrev_b32 v47, 5, v0
    v_lshl_add_u32 v3, v47, 3, v44
    v_lshl_add_u32 v41, v3, 6, v45
    v_lshl_add_u32 v41, v46, 5, v41
    v_add_u32 v40, 147712, v41
    v_add_u32 v42, 65536, v41
    v_mul_u32_u24 v8, 192, v3
    v_add_u32 v8, v8, v45
    v_mul_u32_u24 v3, 3104, v46
    v_add_u32 v8, v8, v3
    v_add_u32 v9, 65536, v8
    s_mul_i32 s79, s5, 43
    s_lshr_b32 s79, s79, 7
    s_mul_i32 s80, s79, 3
    s_sub_u32 s80, s5, s80
    s_mul_i32 s80, s80, 6
    s_lshl_b32 s82, s79, 4
    s_add_u32 s82, s82, s80
    s_lshl_b32 s79, s82, 5
    v_add_u32 v3, 0, v0
    v_mul_u32_u24 v44, 43691, v3
    v_lshrrev_b32 v44, 19, v44
    v_mul_u32_u24 v45, 12, v44
    v_sub_u32 v45, v3, v45
    v_mul_u32_u24 v44, 2752, v44
    v_lshl_add_u32 v44, v45, 4, v44
    v_add_u32 v10, s79, v44
    v_add_u32 v3, 64, v0
    v_mul_u32_u24 v44, 43691, v3
    v_lshrrev_b32 v44, 19, v44
    v_mul_u32_u24 v45, 12, v44
    v_sub_u32 v45, v3, v45
    v_mul_u32_u24 v44, 2752, v44
    v_lshl_add_u32 v44, v45, 4, v44
    v_add_u32 v11, s79, v44
    v_add_u32 v3, 128, v0
    v_mul_u32_u24 v44, 43691, v3
    v_lshrrev_b32 v44, 19, v44
    v_mul_u32_u24 v45, 12, v44
    v_sub_u32 v45, v3, v45
    v_mul_u32_u24 v44, 2752, v44
    v_lshl_add_u32 v44, v45, 4, v44
    v_add_u32 v12, s79, v44
    s_cmp_lg_u32 s100, 0
    s_cbranch_scc1 L_G_kv
    s_waitcnt vmcnt(0) lgkmcnt(0)
    s_add_u32 s76, s76, 1
    s_addc_u32 s77, s77, 0
    v_mov_b32 v6, s76
    v_mov_b32 v7, s77
    s_branch L_G_tagged
L_G_kv:
    v_and_b32 v52, 15, v0
    v_lshrrev_b32 v53, 4, v0
    v_lshrrev_b32 v54, 1, v52
    v_xor_b32 v54, v54, v53
    v_lshlrev_b32 v54, 4, v54
    v_lshl_add_u32 v54, v52, 7, v54
    v_add_u32 v48, s90, v54
    v_xor_b32 v49, 64, v48
    v_lshlrev_b32 v54, 3, v52
    v_lshl_add_u32 v54, v53, 8, v54
    v_add_u32 v50, 131072, v54
    v_lshlrev_b32 v51, 4, v52
    v_lshrrev_b32 v54, 5, v0
    v_and_b32 v53, 1, v53
    s_lshl_b32 s80, s7, 11
    s_cmp_ge_u32 s5, 8
    s_cbranch_scc1 L_G_kvV
    v_lshl_add_u32 v51, v53, 9, v51
    v_lshl_add_u32 v51, v54, 3, v51
    s_lshl_b32 s79, s34, 8
    s_add_u32 s80, s80, s79
    s_add_u32 s80, s80, 327680
    s_waitcnt vmcnt(16) lgkmcnt(0)
    ds_read_b128 v[128:131], v48 offset:24576
    ds_read_b64_tr_b16 v[132:133], v50 offset:0
    ds_read_b64_tr_b16 v[134:135], v50 offset:128
    ds_read_b128 v[136:139], v49 offset:24576
    ds_read_b64_tr_b16 v[140:141], v50 offset:1024
    ds_read_b64_tr_b16 v[142:143], v50 offset:1152
    ds_read_b128 v[144:147], v48 offset:28672
    ds_read_b64_tr_b16 v[148:149], v50 offset:2048
    ds_read_b64_tr_b16 v[150:151], v50 offset:2176
    ds_read_b128 v[152:155], v49 offset:28672
    ds_read_b64_tr_b16 v[156:157], v50 offset:3072
    ds_read_b64_tr_b16 v[158:159], v50 offset:3200
    s_waitcnt lgkmcnt(9)
    v_mfma_f32_16x16x32_bf16 v[56:59], v[132:135], v[128:131], 0
    ds_read_b128 v[160:163], v48 offset:0
    ds_read_b64_tr_b16 v[164:165], v50 offset:4096
    ds_read_b64_tr_b16 v[166:167], v50 offset:4224
    s_waitcnt lgkmcnt(9)
    v_mfma_f32_16x16x32_bf16 v[56:59], v[140:143], v[136:139], v[56:59]
    ds_read_b128 v[168:171], v49 offset:0
    ds_read_b64_tr_b16 v[172:173], v50 offset:5120
    ds_read_b64_tr_b16 v[174:175], v50 offset:5248
    s_waitcnt lgkmcnt(9)
    v_mfma_f32_16x16x32_bf16 v[56:59], v[148:151], v[144:147], v[56:59]
    ds_read_b128 v[176:179], v48 offset:4096
    ds_read_b64_tr_b16 v[180:181], v50 offset:6144
    ds_read_b64_tr_b16 v[182:183], v50 offset:6272
    s_waitcnt lgkmcnt(9)
    v_mfma_f32_16x16x32_bf16 v[56:59], v[156:159], v[152:155], v[56:59]
    ds_read_b128 v[184:187], v49 offset:4096
    ds_read_b64_tr_b16 v[188:189], v50 offset:7168
    ds_read_b64_tr_b16 v[190:191], v50 offset:7296
    s_waitcnt vmcnt(0)
    s_waitcnt lgkmcnt(9)
    v_mfma_f32_16x16x32_bf16 v[56:59], v[164:167], v[160:163], v[56:59]
    ds_read_b128 v[192:195], v48 offset:8192
    ds_read_b64_tr_b16 v[196:197], v50 offset:8192
    ds_read_b64_tr_b16 v[198:199], v50 offset:8320
    s_waitcnt lgkmcnt(9)
    v_mfma_f32_16x16x32_bf16 v[56:59], v[172:175], v[168:171], v[56:59]
    ds_read_b128 v[200:203], v49 offset:8192
    ds_read_b64_tr_b16 v[204:205], v50 offset:9216
    ds_read_b64_tr_b16 v[206:207], v50 offset:9344
    s_waitcnt lgkmcnt(9)
    v_mfma_f32_16x16x32_bf16 v[56:59], v[180:183], v[176:179], v[56:59]
    ds_read_b128 v[208:211], v48 offset:12288
    ds_read_b64_tr_b16 v[212:213], v50 offset:10240
    ds_read_b64_tr_b16 v[214:215], v50 offset:10368
    s_waitcnt lgkmcnt(9)
    v_mfma_f32_16x16x32_bf16 v[56:59], v[188:191], v[184:187], v[56:59]
    ds_read_b128 v[216:219], v49 offset:12288
    ds_read_b64_tr_b16 v[220:221], v50 offset:11264
    ds_read_b64_tr_b16 v[222:223], v50 offset:11392
    s_waitcnt lgkmcnt(9)
    v_mfma_f32_16x16x32_bf16 v[56:59], v[196:199], v[192:195], v[56:59]
    ds_read_b128 v[224:227], v48 offset:16384
    ds_read_b64_tr_b16 v[228:229], v50 offset:12288
    ds_read_b64_tr_b16 v[230:231], v50 offset:12416
    s_waitcnt lgkmcnt(9)
    v_mfma_f32_16x16x32_bf16 v[56:59], v[204:207], v[200:203], v[56:59]
    ds_read_b128 v[232:235], v49 offset:16384
    ds_read_b64_tr_b16 v[236:237], v50 offset:13312
    ds_read_b64_tr_b16 v[238:239], v50 offset:13440
    s_waitcnt lgkmcnt(9)
    v_mfma_f32_16x16x32_bf16 v[56:59], v[212:215], v[208:211], v[56:59]
    ds_read_b128 v[240:243], v48 offset:20480
    ds_read_b64_tr_b16 v[244:245], v50 offset:14336
    ds_read_b64_tr_b16 v[246:247], v50 offset:14464
    s_waitcnt lgkmcnt(9)
    v_mfma_f32_16x16x32_bf16 v[56:59], v[220:223], v[216:219], v[56:59]
    ds_read_b128 v[248:251], v49 offset:20480
    ds_read_b64_tr_b16 v[252:253], v50 offset:15360
    ds_read_b64_tr_b16 v[254:255], v50 offset:15488
    s_waitcnt lgkmcnt(9)
    v_mfma_f32_16x16x32_bf16 v[56:59], v[228:231], v[224:227], v[56:59]
    s_waitcnt lgkmcnt(6)
    v_mfma_f32_16x16x32_bf16 v[56:59], v[236:239], v[232:235], v[56:59]
    s_waitcnt lgkmcnt(3)
    v_mfma_f32_16x16x32_bf16 v[56:59], v[244:247], v[240:243], v[56:59]
    s_waitcnt lgkmcnt(0)
    v_mfma_f32_16x16x32_bf16 v[56:59], v[252:255], v[248:251], v[56:59]
    s_nop 7
    v_mul_f32 v56, 0x3eb8aa3b, v56
    v_mul_f32 v57, 0x3eb8aa3b, v57
    v_mul_f32 v58, 0x3eb8aa3b, v58
    v_mul_f32 v59, 0x3eb8aa3b, v59
    v_cvt_pk_bf16_f32 v60, v56, v57
    v_cvt_pk_bf16_f32 v61, v58, v59
    buffer_store_dwordx2 v[60:61], v51, s[72:75], s80 offen sc1
    v_lshrrev_b32 v53, 4, v0
    v_lshlrev_b32 v53, 4, v53
    v_add_u32 v53, 160000, v53
    ds_read_b128 v[64:67], v53 offset:0
    ds_read_b128 v[68:71], v53 offset:64
    ds_read_b128 v[72:75], v53 offset:128
    ds_read_b128 v[76:79], v53 offset:192
    ds_read_b128 v[80:83], v53 offset:256
    ds_read_b128 v[84:87], v53 offset:320
    ds_read_b128 v[88:91], v53 offset:384
    ds_read_b128 v[92:95], v53 offset:448
    ds_read_b128 v[96:99], v53 offset:512
    ds_read_b128 v[100:103], v53 offset:576
    ds_read_b128 v[104:107], v53 offset:640
    ds_read_b128 v[108:111], v53 offset:704
    s_waitcnt lgkmcnt(11)
    ds_read_b128 v[112:115], v53 offset:768
    s_waitcnt lgkmcnt(11)
    ds_read_b128 v[116:119], v53 offset:832
    s_waitcnt lgkmcnt(11)
    ds_read_b128 v[120:123], v53 offset:896
    s_waitcnt lgkmcnt(11)
    ds_read_b128 v[124:127], v53 offset:960
    v_mfma_f32_16x16x32_bf16 v[48:51], v[64:67], v[128:131], 0
    v_mfma_f32_16x16x32_bf16 v[48:51], v[68:71], v[136:139], v[48:51]
    v_mfma_f32_16x16x32_bf16 v[48:51], v[72:75], v[144:147], v[48:51]
    v_mfma_f32_16x16x32_bf16 v[48:51], v[76:79], v[152:155], v[48:51]
    s_waitcnt lgkmcnt(11)
    v_mfma_f32_16x16x32_bf16 v[48:51], v[80:83], v[160:163], v[48:51]
    s_waitcnt lgkmcnt(10)
    v_mfma_f32_16x16x32_bf16 v[48:51], v[84:87], v[168:171], v[48:51]
    s_waitcnt lgkmcnt(9)
    v_mfma_f32_16x16x32_bf16 v[48:51], v[88:91], v[176:179], v[48:51]
    s_waitcnt lgkmcnt(8)
    v_mfma_f32_16x16x32_bf16 v[48:51], v[92:95], v[184:187], v[48:51]
    s_waitcnt lgkmcnt(7)
    v_mfma_f32_16x16x32_bf16 v[48:51], v[96:99], v[192:195], v[48:51]
    s_waitcnt lgkmcnt(6)
    v_mfma_f32_16x16x32_bf16 v[48:51], v[100:103], v[200:203], v[48:51]
    s_waitcnt lgkmcnt(5)
    v_mfma_f32_16x16x32_bf16 v[48:51], v[104:107], v[208:211], v[48:51]
    s_waitcnt lgkmcnt(4)
    v_mfma_f32_16x16x32_bf16 v[48:51], v[108:111], v[216:219], v[48:51]
    s_waitcnt lgkmcnt(3)
    v_mfma_f32_16x16x32_bf16 v[48:51], v[112:115], v[224:227], v[48:51]
    s_waitcnt lgkmcnt(2)
    v_mfma_f32_16x16x32_bf16 v[48:51], v[116:119], v[232:235], v[48:51]
    s_waitcnt lgkmcnt(1)
    v_mfma_f32_16x16x32_bf16 v[48:51], v[120:123], v[240:243], v[48:51]
    s_waitcnt lgkmcnt(0)
    v_mfma_f32_16x16x32_bf16 v[48:51], v[124:127], v[248:251], v[48:51]
    s_lshl_b32 s80, s7, 7
    s_lshl_b32 s79, s34, 6
    s_add_u32 s80, s80, s79
    s_add_u32 s80, s80, 262144
    v_lshlrev_b32 v53, 2, v0
    s_mov_b64 exec, 0xffff
    s_nop 1
    buffer_store_dword v48, v53, s[72:75], s80 offen sc1
    s_mov_b64 exec, -1
    s_branch L_G_pub
L_G_kvV:
    v_lshl_add_u32 v51, v53, 3, v51
    v_lshl_add_u32 v51, v54, 8, v51
    s_lshl_b32 s79, s34, 9
    s_add_u32 s80, s80, s79
    s_add_u32 s80, s80, 328704
    s_waitcnt vmcnt(16) lgkmcnt(0)
    ds_read_b128 v[128:131], v48 offset:24576
    ds_read_b64_tr_b16 v[132:133], v50 offset:0
    ds_read_b64_tr_b16 v[134:135], v50 offset:128
    ds_read_b128 v[136:139], v49 offset:24576
    ds_read_b64_tr_b16 v[140:141], v50 offset:1024
    ds_read_b64_tr_b16 v[142:143], v50 offset:1152
    ds_read_b128 v[144:147], v48 offset:28672
    ds_read_b64_tr_b16 v[148:149], v50 offset:2048
    ds_read_b64_tr_b16 v[150:151], v50 offset:2176
    ds_read_b128 v[152:155], v49 offset:28672
    ds_read_b64_tr_b16 v[156:157], v50 offset:3072
    ds_read_b64_tr_b16 v[158:159], v50 offset:3200
    s_waitcnt lgkmcnt(9)
    v_mfma_f32_16x16x32_bf16 v[56:59], v[128:131], v[132:135], 0
    ds_read_b128 v[160:163], v48 offset:0
    ds_read_b64_tr_b16 v[164:165], v50 offset:4096
    ds_read_b64_tr_b16 v[166:167], v50 offset:4224
    s_waitcnt lgkmcnt(9)
    v_mfma_f32_16x16x32_bf16 v[56:59], v[136:139], v[140:143], v[56:59]
    ds_read_b128 v[168:171], v49 offset:0
    ds_read_b64_tr_b16 v[172:173], v50 offset:5120
    ds_read_b64_tr_b16 v[174:175], v50 offset:5248
    s_waitcnt lgkmcnt(9)
    v_mfma_f32_16x16x32_bf16 v[56:59], v[144:147], v[148:151], v[56:59]
    ds_read_b128 v[176:179], v48 offset:4096
    ds_read_b64_tr_b16 v[180:181], v50 offset:6144
    ds_read_b64_tr_b16 v[182:183], v50 offset:6272
    s_waitcnt lgkmcnt(9)
    v_mfma_f32_16x16x32_bf16 v[56:59], v[152:155], v[156:159], v[56:59]
    ds_read_b128 v[184:187], v49 offset:4096
    ds_read_b64_tr_b16 v[188:189], v50 offset:7168
    ds_read_b64_tr_b16 v[190:191], v50 offset:7296
    s_waitcnt vmcnt(0)
    s_waitcnt lgkmcnt(9)
    v_mfma_f32_16x16x32_bf16 v[56:59], v[160:163], v[164:167], v[56:59]
    ds_read_b128 v[192:195], v48 offset:8192
    ds_read_b64_tr_b16 v[196:197], v50 offset:8192
    ds_read_b64_tr_b16 v[198:199], v50 offset:8320
    s_waitcnt lgkmcnt(9)
    v_mfma_f32_16x16x32_bf16 v[56:59], v[168:171], v[172:175], v[56:59]
    ds_read_b128 v[200:203], v49 offset:8192
    ds_read_b64_tr_b16 v[204:205], v50 offset:9216
    ds_read_b64_tr_b16 v[206:207], v50 offset:9344
    s_waitcnt lgkmcnt(9)
    v_mfma_f32_16x16x32_bf16 v[56:59], v[176:179], v[180:183], v[56:59]
    ds_read_b128 v[208:211], v48 offset:12288
    ds_read_b64_tr_b16 v[212:213], v50 offset:10240
    ds_read_b64_tr_b16 v[214:215], v50 offset:10368
    s_waitcnt lgkmcnt(9)
    v_mfma_f32_16x16x32_bf16 v[56:59], v[184:187], v[188:191], v[56:59]
    ds_read_b128 v[216:219], v49 offset:12288
    ds_read_b64_tr_b16 v[220:221], v50 offset:11264
    ds_read_b64_tr_b16 v[222:223], v50 offset:11392
    s_waitcnt lgkmcnt(9)
    v_mfma_f32_16x16x32_bf16 v[56:59], v[192:195], v[196:199], v[56:59]
    ds_read_b128 v[224:227], v48 offset:16384
    ds_read_b64_tr_b16 v[228:229], v50 offset:12288
    ds_read_b64_tr_b16 v[230:231], v50 offset:12416
    s_waitcnt lgkmcnt(9)
    v_mfma_f32_16x16x32_bf16 v[56:59], v[200:203], v[204:207], v[56:59]
    ds_read_b128 v[232:235], v49 offset:16384
    ds_read_b64_tr_b16 v[236:237], v50 offset:13312
    ds_read_b64_tr_b16 v[238:239], v50 offset:13440
    s_waitcnt lgkmcnt(9)
    v_mfma_f32_16x16x32_bf16 v[56:59], v[208:211], v[212:215], v[56:59]
    ds_read_b128 v[240:243], v48 offset:20480
    ds_read_b64_tr_b16 v[244:245], v50 offset:14336
    ds_read_b64_tr_b16 v[246:247], v50 offset:14464
    s_waitcnt lgkmcnt(9)
    v_mfma_f32_16x16x32_bf16 v[56:59], v[216:219], v[220:223], v[56:59]
    ds_read_b128 v[248:251], v49 offset:20480
    ds_read_b64_tr_b16 v[252:253], v50 offset:15360
    ds_read_b64_tr_b16 v[254:255], v50 offset:15488
    s_waitcnt lgkmcnt(9)
    v_mfma_f32_16x16x32_bf16 v[56:59], v[224:227], v[228:231], v[56:59]
    s_waitcnt lgkmcnt(6)
    v_mfma_f32_16x16x32_bf16 v[56:59], v[232:235], v[236:239], v[56:59]
    s_waitcnt lgkmcnt(3)
    v_mfma_f32_16x16x32_bf16 v[56:59], v[240:243], v[244:247], v[56:59]
    s_waitcnt lgkmcnt(0)
    v_mfma_f32_16x16x32_bf16 v[56:59], v[248:251], v[252:255], v[56:59]
    s_nop 7
    v_cvt_pk_bf16_f32 v60, v56, v57
    v_cvt_pk_bf16_f32 v61, v58, v59
    buffer_store_dwordx2 v[60:61], v51, s[72:75], s80 offen sc1
    s_waitcnt vmcnt(0)
    s_branch L_G_pub
L_G_pub:
    ds_add_u32 v1, v2 offset:120
    s_add_u32 s76, s76, 1
    s_addc_u32 s77, s77, 0
    v_mov_b32 v6, s76
    v_mov_b32 v7, s77
    s_lshl_b32 s79, s7, 2
    s_lshl_b32 s80, s34, 1
    s_add_u32 s79, s79, s80
    s_lshr_b32 s80, s5, 3
    s_add_u32 s79, s79, s80
    s_lshl_b32 s79, s79, 7
    s_add_u32 s88, s79, 4096
    s_waitcnt vmcnt(1)
    s_mov_b64 exec, 1
    buffer_store_dwordx2 v[6:7], off, s[72:75], s88 sc1
    s_mov_b64 exec, -1
L_G_tagged:
    ds_read_b32 v3, v5 offset:24
    s_waitcnt lgkmcnt(0)
    v_readfirstlane_b32 s84, v3
    s_cmp_ge_u32 s84, 1
    s_cbranch_scc0 L_spin_2
L_ok_1:
    ds_read_b128 v[128:131], v34 offset:24576
    ds_read_b128 v[132:135], v35 offset:24576
    ds_read_b128 v[136:139], v36 offset:24576
    ds_read_b128 v[140:143], v37 offset:24576
    ds_read_b128 v[144:147], v34 offset:28672
    ds_read_b128 v[148:151], v35 offset:28672
    ds_read_b128 v[152:155], v36 offset:28672
    ds_read_b128 v[156:159], v37 offset:28672
    ds_add_u32 v5, v2 offset:0
    s_cmp_eq_u32 s100, 0
    s_cbranch_scc1 L_G_nf2
    s_cmp_ge_u32 s5, 8
    s_cbranch_scc1 L_G_nf2
    s_waitcnt vmcnt(0)
    s_mov_b64 exec, 1
    s_add_u32 s88, s88, 225280
    buffer_store_dwordx2 v[6:7], off, s[72:75], s88 sc1
    s_mov_b64 exec, -1
L_G_nf2:
    ds_read_b32 v3, v1 offset:0
    s_waitcnt lgkmcnt(0)
    v_readfirstlane_b32 s84, v3
    s_cmp_ge_u32 s84, 4
    s_cbranch_scc0 L_spin_4
L_ok_3:
    ds_read_b64_tr_b16 v[80:81], v40 offset:0
    ds_read_b64_tr_b16 v[82:83], v40 offset:256
    ds_read_b64_tr_b16 v[84:85], v40 offset:1024
    ds_read_b64_tr_b16 v[86:87], v40 offset:1280
    ds_read_b64_tr_b16 v[88:89], v40 offset:2048
    ds_read_b64_tr_b16 v[90:91], v40 offset:2304
    ds_read_b64_tr_b16 v[92:93], v40 offset:3072
    ds_read_b64_tr_b16 v[94:95], v40 offset:3328
    ds_read_b64_tr_b16 v[96:97], v40 offset:4096
    ds_read_b64_tr_b16 v[98:99], v40 offset:4352
    s_waitcnt lgkmcnt(8)
    v_mfma_f32_32x32x16_bf16 v[48:63], v[80:83], v[128:131], 0
    ds_read_b64_tr_b16 v[100:101], v40 offset:5120
    ds_read_b64_tr_b16 v[102:103], v40 offset:5376
    s_waitcnt lgkmcnt(8)
    v_mfma_f32_32x32x16_bf16 v[48:63], v[84:87], v[132:135], v[48:63]
    ds_read_b64_tr_b16 v[80:81], v40 offset:6144
    ds_read_b64_tr_b16 v[82:83], v40 offset:6400
    s_waitcnt lgkmcnt(8)
    v_mfma_f32_32x32x16_bf16 v[48:63], v[88:91], v[136:139], v[48:63]
    ds_read_b64_tr_b16 v[84:85], v40 offset:7168
    ds_read_b64_tr_b16 v[86:87], v40 offset:7424
    s_waitcnt lgkmcnt(8)
    v_mfma_f32_32x32x16_bf16 v[48:63], v[92:95], v[140:143], v[48:63]
    s_waitcnt lgkmcnt(6)
    v_mfma_f32_32x32x16_bf16 v[48:63], v[96:99], v[144:147], v[48:63]
    s_waitcnt lgkmcnt(4)
    v_mfma_f32_32x32x16_bf16 v[48:63], v[100:103], v[148:151], v[48:63]
    s_waitcnt lgkmcnt(2)
    v_mfma_f32_32x32x16_bf16 v[48:63], v[80:83], v[152:155], v[48:63]
    s_waitcnt lgkmcnt(0)
    v_mfma_f32_32x32x16_bf16 v[48:63], v[84:87], v[156:159], v[48:63]
    ds_read_b32 v3, v5 offset:24
    s_waitcnt lgkmcnt(0)
    v_readfirstlane_b32 s84, v3
    s_cmp_ge_u32 s84, 2
    s_cbranch_scc0 L_spin_6
L_ok_5:
    ds_read_b128 v[160:163], v34 offset:0
    ds_read_b128 v[164:167], v35 offset:0
    ds_read_b128 v[168:171], v36 offset:0
    ds_read_b128 v[172:175], v37 offset:0
    ds_read_b128 v[176:179], v34 offset:4096
    ds_read_b128 v[180:183], v35 offset:4096
    ds_read_b128 v[184:187], v36 offset:4096
    ds_read_b128 v[188:191], v37 offset:4096
    s_waitcnt lgkmcnt(4)
    ds_read_b64_tr_b16 v[88:89], v40 offset:8192
    ds_read_b64_tr_b16 v[90:91], v40 offset:8448
    ds_read_b64_tr_b16 v[92:93], v40 offset:9216
    ds_read_b64_tr_b16 v[94:95], v40 offset:9472
    ds_read_b64_tr_b16 v[96:97], v40 offset:10240
    ds_read_b64_tr_b16 v[98:99], v40 offset:10496
    ds_read_b64_tr_b16 v[100:101], v40 offset:11264
    ds_read_b64_tr_b16 v[102:103], v40 offset:11520
    s_waitcnt lgkmcnt(6)
    v_mfma_f32_32x32x16_bf16 v[48:63], v[88:91], v[160:163], v[48:63]
    s_waitcnt lgkmcnt(4)
    v_mfma_f32_32x32x16_bf16 v[48:63], v[92:95], v[164:167], v[48:63]
    s_waitcnt lgkmcnt(2)
    v_mfma_f32_32x32x16_bf16 v[48:63], v[96:99], v[168:171], v[48:63]
    s_waitcnt lgkmcnt(0)
    v_mfma_f32_32x32x16_bf16 v[48:63], v[100:103], v[172:175], v[48:63]
    ds_read_b32 v3, v1 offset:4
    s_waitcnt lgkmcnt(0)
    v_readfirstlane_b32 s84, v3
    s_cmp_ge_u32 s84, 4
    s_cbranch_scc0 L_spin_8
L_ok_7:
    ds_read_b64_tr_b16 v[80:81], v41 offset:24704
    ds_read_b64_tr_b16 v[82:83], v41 offset:24960
    ds_read_b64_tr_b16 v[84:85], v41 offset:25728
    ds_read_b64_tr_b16 v[86:87], v41 offset:25984
    ds_read_b64_tr_b16 v[88:89], v41 offset:26752
    ds_read_b64_tr_b16 v[90:91], v41 offset:27008
    ds_read_b64_tr_b16 v[92:93], v41 offset:27776
    ds_read_b64_tr_b16 v[94:95], v41 offset:28032
    s_waitcnt lgkmcnt(6)
    v_mfma_f32_32x32x16_bf16 v[48:63], v[80:83], v[176:179], v[48:63]
    s_waitcnt lgkmcnt(4)
    v_mfma_f32_32x32x16_bf16 v[48:63], v[84:87], v[180:183], v[48:63]
    s_waitcnt lgkmcnt(2)
    v_mfma_f32_32x32x16_bf16 v[48:63], v[88:91], v[184:187], v[48:63]
    s_waitcnt lgkmcnt(0)
    v_mfma_f32_32x32x16_bf16 v[48:63], v[92:95], v[188:191], v[48:63]
    ds_read_b32 v3, v5 offset:24
    s_waitcnt lgkmcnt(0)
    v_readfirstlane_b32 s84, v3
    s_cmp_ge_u32 s84, 3
    s_cbranch_scc0 L_spin_10
L_ok_9:
    ds_read_b128 v[192:195], v34 offset:8192
    ds_read_b128 v[196:199], v35 offset:8192
    ds_read_b128 v[200:203], v36 offset:8192
    ds_read_b128 v[204:207], v37 offset:8192
    ds_read_b128 v[208:211], v34 offset:12288
    ds_read_b128 v[212:215], v35 offset:12288
    ds_read_b128 v[216:219], v36 offset:12288
    ds_read_b128 v[220:223], v37 offset:12288
    s_waitcnt lgkmcnt(4)
    ds_read_b64_tr_b16 v[96:97], v41 offset:28800
    ds_read_b64_tr_b16 v[98:99], v41 offset:29056
    ds_read_b64_tr_b16 v[100:101], v41 offset:57472
    ds_read_b64_tr_b16 v[102:103], v41 offset:57728
    ds_read_b64_tr_b16 v[80:81], v41 offset:58496
    ds_read_b64_tr_b16 v[82:83], v41 offset:58752
    ds_read_b64_tr_b16 v[84:85], v41 offset:59520
    ds_read_b64_tr_b16 v[86:87], v41 offset:59776
    ds_read_b64_tr_b16 v[88:89], v41 offset:60544
    ds_read_b64_tr_b16 v[90:91], v41 offset:60800
    s_waitcnt lgkmcnt(8)
    v_mfma_f32_32x32x16_bf16 v[48:63], v[96:99], v[192:195], v[48:63]
    ds_read_b64_tr_b16 v[92:93], v41 offset:61568
    ds_read_b64_tr_b16 v[94:95], v41 offset:61824
    s_waitcnt lgkmcnt(8)
    v_mfma_f32_32x32x16_bf16 v[48:63], v[100:103], v[196:199], v[48:63]
    ds_read_b64_tr_b16 v[96:97], v42 offset:24704
    ds_read_b64_tr_b16 v[98:99], v42 offset:24960
    s_waitcnt lgkmcnt(8)
    v_mfma_f32_32x32x16_bf16 v[48:63], v[80:83], v[200:203], v[48:63]
    ds_read_b64_tr_b16 v[100:101], v42 offset:25728
    ds_read_b64_tr_b16 v[102:103], v42 offset:25984
    s_waitcnt lgkmcnt(8)
    v_mfma_f32_32x32x16_bf16 v[48:63], v[84:87], v[204:207], v[48:63]
    s_waitcnt lgkmcnt(6)
    v_mfma_f32_32x32x16_bf16 v[48:63], v[88:91], v[208:211], v[48:63]
    s_waitcnt lgkmcnt(4)
    v_mfma_f32_32x32x16_bf16 v[48:63], v[92:95], v[212:215], v[48:63]
    s_waitcnt lgkmcnt(2)
    v_mfma_f32_32x32x16_bf16 v[48:63], v[96:99], v[216:219], v[48:63]
    s_waitcnt lgkmcnt(0)
    v_mfma_f32_32x32x16_bf16 v[48:63], v[100:103], v[220:223], v[48:63]
    ds_read_b32 v3, v5 offset:24
    s_waitcnt lgkmcnt(0)
    v_readfirstlane_b32 s84, v3
    s_cmp_ge_u32 s84, 4
    s_cbranch_scc0 L_spin_12
L_ok_11:
    ds_read_b128 v[224:227], v34 offset:16384
    ds_read_b128 v[228:231], v35 offset:16384
    ds_read_b128 v[232:235], v36 offset:16384
    ds_read_b128 v[236:239], v37 offset:16384
    ds_read_b128 v[240:243], v34 offset:20480
    ds_read_b128 v[244:247], v35 offset:20480
    ds_read_b128 v[248:251], v36 offset:20480
    ds_read_b128 v[252:255], v37 offset:20480
    s_waitcnt lgkmcnt(4)
    ds_read_b64_tr_b16 v[80:81], v42 offset:26752
    ds_read_b64_tr_b16 v[82:83], v42 offset:27008
    ds_read_b64_tr_b16 v[84:85], v42 offset:27776
    ds_read_b64_tr_b16 v[86:87], v42 offset:28032
    ds_read_b64_tr_b16 v[88:89], v42 offset:28800
    ds_read_b64_tr_b16 v[90:91], v42 offset:29056
    ds_read_b64_tr_b16 v[92:93], v42 offset:57472
    ds_read_b64_tr_b16 v[94:95], v42 offset:57728
    ds_read_b64_tr_b16 v[96:97], v42 offset:58496
    ds_read_b64_tr_b16 v[98:99], v42 offset:58752
    s_waitcnt lgkmcnt(8)
    v_mfma_f32_32x32x16_bf16 v[48:63], v[80:83], v[224:227], v[48:63]
    ds_read_b64_tr_b16 v[100:101], v42 offset:59520
    ds_read_b64_tr_b16 v[102:103], v42 offset:59776
    s_waitcnt lgkmcnt(8)
    v_mfma_f32_32x32x16_bf16 v[48:63], v[84:87], v[228:231], v[48:63]
    ds_read_b64_tr_b16 v[80:81], v42 offset:60544
    ds_read_b64_tr_b16 v[82:83], v42 offset:60800
    s_waitcnt lgkmcnt(8)
    v_mfma_f32_32x32x16_bf16 v[48:63], v[88:91], v[232:235], v[48:63]
    ds_read_b64_tr_b16 v[84:85], v42 offset:61568
    ds_read_b64_tr_b16 v[86:87], v42 offset:61824
    s_waitcnt lgkmcnt(8)
    v_mfma_f32_32x32x16_bf16 v[48:63], v[92:95], v[236:239], v[48:63]
    s_waitcnt lgkmcnt(6)
    v_mfma_f32_32x32x16_bf16 v[48:63], v[96:99], v[240:243], v[48:63]
    s_waitcnt lgkmcnt(4)
    v_mfma_f32_32x32x16_bf16 v[48:63], v[100:103], v[244:247], v[48:63]
    s_waitcnt lgkmcnt(2)
    v_mfma_f32_32x32x16_bf16 v[48:63], v[80:83], v[248:251], v[48:63]
    s_waitcnt lgkmcnt(0)
    v_mfma_f32_32x32x16_bf16 v[48:63], v[84:87], v[252:255], v[48:63]
    v_add_u32 v3, s78, v4
    s_nop 10
    v_cvt_pk_bf16_f32 v80, v48, v49
    v_cvt_pk_bf16_f32 v81, v50, v51
    v_cvt_pk_bf16_f32 v82, v52, v53
    v_cvt_pk_bf16_f32 v83, v54, v55
    v_cvt_pk_bf16_f32 v84, v56, v57
    v_cvt_pk_bf16_f32 v85, v58, v59
    v_cvt_pk_bf16_f32 v86, v60, v61
    v_cvt_pk_bf16_f32 v87, v62, v63
    ds_write_b128 v3, v[80:83] offset:29824
    ds_write_b128 v3, v[84:87] offset:30848
    ds_add_u32 v5, v2 offset:0
    ds_add_u32 v1, v2 offset:8
    ds_read_b32 v3, v1 offset:100
    s_waitcnt lgkmcnt(0)
    s_setprio 2
    v_readfirstlane_b32 s84, v3
    s_setprio 0
    s_cmp_ge_u32 s84, 4
    s_cbranch_scc0 L_spin_14
L_ok_13:
    s_add_u32 s81, s101, 0
    s_and_b32 s81, s81, 7
    s_lshl_b32 s81, s81, 2
    s_add_u32 s81, s81, s6
    s_mul_i32 s81, s81, 44032
    s_add_u32 m0, s78, 0
    s_nop 0
    buffer_load_dwordx4 v10, s[52:55], s81 offen  lds
    s_add_u32 m0, s78, 1024
    s_nop 0
    buffer_load_dwordx4 v11, s[52:55], s81 offen  lds
    s_add_u32 m0, s78, 2048
    s_nop 0
    buffer_load_dwordx4 v12, s[52:55], s81 offen  lds
    s_add_u32 m0, s78, 3104
    s_nop 0
    buffer_load_dwordx4 v10, s[56:59], s81 offen  lds
    s_add_u32 m0, s78, 4128
    s_nop 0
    buffer_load_dwordx4 v11, s[56:59], s81 offen  lds
    s_add_u32 m0, s78, 5152
    s_nop 0
    buffer_load_dwordx4 v12, s[56:59], s81 offen  lds
    s_add_u32 s81, s101, 1
    s_and_b32 s81, s81, 7
    s_lshl_b32 s81, s81, 2
    s_add_u32 s81, s81, s6
    s_mul_i32 s81, s81, 44032
    s_add_u32 m0, s78, 6176
    s_nop 0
    buffer_load_dwordx4 v10, s[52:55], s81 offen  lds
    s_add_u32 m0, s78, 7200
    s_nop 0
    buffer_load_dwordx4 v11, s[52:55], s81 offen  lds
    s_add_u32 m0, s78, 8224
    s_nop 0
    buffer_load_dwordx4 v12, s[52:55], s81 offen  lds
    s_add_u32 m0, s78, 9280
    s_nop 0
    buffer_load_dwordx4 v10, s[56:59], s81 offen  lds
    s_add_u32 m0, s78, 10304
    s_nop 0
    buffer_load_dwordx4 v11, s[56:59], s81 offen  lds
    s_add_u32 m0, s78, 11328
    s_nop 0
    buffer_load_dwordx4 v12, s[56:59], s81 offen  lds
    s_mul_i32 s79, s5, 43
    s_lshr_b32 s79, s79, 7
    s_mul_i32 s79, s79, 3
    s_add_u32 s79, s79, 2
    s_cmp_eq_u32 s79, s5
    s_cselect_b64 vcc, -1, 0
    s_waitcnt vmcnt(6)
    ds_add_u32 v1, v2 offset:16
    ds_read_b32 v3, v1 offset:16
    s_waitcnt lgkmcnt(0)
    s_setprio 2
    v_readfirstlane_b32 s84, v3
    s_setprio 0
    s_cmp_ge_u32 s84, 4
    s_cbranch_scc0 L_spin_16
L_ok_15:
    ds_read_b64_tr_b16 v[16:17], v8 offset:0
    ds_read_b64_tr_b16 v[18:19], v8 offset:768
    ds_read_b64_tr_b16 v[20:21], v8 offset:32
    ds_read_b64_tr_b16 v[24:25], v8 offset:64
    s_waitcnt lgkmcnt(2)
    v_mfma_f32_32x32x16_bf16 v[32:47], v[16:19], v[128:131], 0
    ds_read_b64_tr_b16 v[22:23], v8 offset:800
    ds_read_b64_tr_b16 v[28:29], v8 offset:96
    s_add_u32 s81, s101, 2
    s_and_b32 s81, s81, 7
    s_lshl_b32 s81, s81, 2
    s_add_u32 s81, s81, s6
    s_mul_i32 s81, s81, 44032
    s_add_u32 m0, s78, 12352
    s_nop 0
    buffer_load_dwordx4 v10, s[52:55], s81 offen  lds
    s_waitcnt lgkmcnt(1)
    v_mfma_f32_32x32x16_bf16 v[48:63], v[20:23], v[128:131], 0
    ds_read_b64_tr_b16 v[26:27], v8 offset:832
    ds_read_b64_tr_b16 v[16:17], v8 offset:128
    s_waitcnt lgkmcnt(1)
    v_mfma_f32_32x32x16_bf16 v[64:79], v[24:27], v[128:131], 0
    ds_read_b64_tr_b16 v[30:31], v8 offset:864
    ds_read_b64_tr_b16 v[20:21], v8 offset:160
    s_add_u32 m0, s78, 13376
    s_nop 0
    buffer_load_dwordx4 v11, s[52:55], s81 offen  lds
    s_waitcnt lgkmcnt(1)
    v_mfma_f32_32x32x16_bf16 v[80:95], v[28:31], v[128:131], 0
    ds_read_b64_tr_b16 v[18:19], v8 offset:896
    ds_read_b64_tr_b16 v[24:25], v8 offset:32768
    s_waitcnt lgkmcnt(1)
    s_cbranch_vccnz L_sk_17
    v_mfma_f32_32x32x16_bf16 v[96:111], v[16:19], v[128:131], 0
L_sk_17:
    ds_read_b64_tr_b16 v[22:23], v8 offset:928
    ds_read_b64_tr_b16 v[28:29], v8 offset:32800
    s_add_u32 m0, s78, 14400
    s_nop 0
    buffer_load_dwordx4 v12, s[52:55], s81 offen  lds
    s_waitcnt lgkmcnt(1)
    s_cbranch_vccnz L_sk_18
    v_mfma_f32_32x32x16_bf16 v[112:127], v[20:23], v[128:131], 0
L_sk_18:
    ds_read_b64_tr_b16 v[26:27], v8 offset:33536
    ds_read_b64_tr_b16 v[16:17], v8 offset:32832
    s_waitcnt lgkmcnt(1)
    v_mfma_f32_32x32x16_bf16 v[32:47], v[24:27], v[132:135], v[32:47]
    ds_read_b64_tr_b16 v[30:31], v8 offset:33568
    ds_read_b64_tr_b16 v[20:21], v8 offset:32864
    s_add_u32 m0, s78, 15456
    s_nop 0
    buffer_load_dwordx4 v10, s[56:59], s81 offen  lds
    s_waitcnt lgkmcnt(1)
    v_mfma_f32_32x32x16_bf16 v[48:63], v[28:31], v[132:135], v[48:63]
    ds_read_b64_tr_b16 v[18:19], v8 offset:33600
    ds_read_b64_tr_b16 v[24:25], v8 offset:32896
    s_waitcnt lgkmcnt(1)
    v_mfma_f32_32x32x16_bf16 v[64:79], v[16:19], v[132:135], v[64:79]
    ds_read_b64_tr_b16 v[22:23], v8 offset:33632
    ds_read_b64_tr_b16 v[28:29], v8 offset:32928
    s_add_u32 m0, s78, 16480
    s_nop 0
    buffer_load_dwordx4 v11, s[56:59], s81 offen  lds
    s_waitcnt lgkmcnt(1)
    v_mfma_f32_32x32x16_bf16 v[80:95], v[20:23], v[132:135], v[80:95]
    ds_read_b64_tr_b16 v[26:27], v8 offset:33664
    ds_read_b64_tr_b16 v[16:17], v9 offset:0
    s_waitcnt lgkmcnt(1)
    s_cbranch_vccnz L_sk_19
    v_mfma_f32_32x32x16_bf16 v[96:111], v[24:27], v[132:135], v[96:111]
L_sk_19:
    ds_read_b64_tr_b16 v[30:31], v8 offset:33696
    ds_read_b64_tr_b16 v[20:21], v9 offset:32
    s_add_u32 m0, s78, 17504
    s_nop 0
    buffer_load_dwordx4 v12, s[56:59], s81 offen  lds
    s_waitcnt lgkmcnt(1)
    s_cbranch_vccnz L_sk_20
    v_mfma_f32_32x32x16_bf16 v[112:127], v[28:31], v[132:135], v[112:127]
L_sk_20:
    ds_read_b64_tr_b16 v[18:19], v9 offset:768
    ds_read_b64_tr_b16 v[24:25], v9 offset:64
    s_waitcnt vmcnt(6)
    ds_add_u32 v1, v2 offset:20
    s_waitcnt lgkmcnt(2)
    v_mfma_f32_32x32x16_bf16 v[32:47], v[16:19], v[136:139], v[32:47]
    ds_read_b64_tr_b16 v[22:23], v9 offset:800
    ds_read_b64_tr_b16 v[28:29], v9 offset:96
    s_waitcnt lgkmcnt(1)
    v_mfma_f32_32x32x16_bf16 v[48:63], v[20:23], v[136:139], v[48:63]
    ds_read_b64_tr_b16 v[26:27], v9 offset:832
    ds_read_b64_tr_b16 v[16:17], v9 offset:128
    s_waitcnt lgkmcnt(1)
    v_mfma_f32_32x32x16_bf16 v[64:79], v[24:27], v[136:139], v[64:79]
    ds_read_b64_tr_b16 v[30:31], v9 offset:864
    ds_read_b64_tr_b16 v[20:21], v9 offset:160
    s_waitcnt lgkmcnt(1)
    v_mfma_f32_32x32x16_bf16 v[80:95], v[28:31], v[136:139], v[80:95]
    ds_read_b64_tr_b16 v[18:19], v9 offset:896
    ds_read_b64_tr_b16 v[24:25], v9 offset:32768
    s_waitcnt lgkmcnt(1)
    s_cbranch_vccnz L_sk_21
    v_mfma_f32_32x32x16_bf16 v[96:111], v[16:19], v[136:139], v[96:111]
L_sk_21:
    ds_read_b64_tr_b16 v[22:23], v9 offset:928
    ds_read_b64_tr_b16 v[28:29], v9 offset:32800
    s_waitcnt lgkmcnt(1)
    s_cbranch_vccnz L_sk_22
    v_mfma_f32_32x32x16_bf16 v[112:127], v[20:23], v[136:139], v[112:127]
L_sk_22:
    ds_read_b64_tr_b16 v[26:27], v9 offset:33536
    ds_read_b64_tr_b16 v[16:17], v9 offset:32832
    ds_read_b32 v3, v1 offset:20
    s_waitcnt lgkmcnt(2)
    v_mfma_f32_32x32x16_bf16 v[32:47], v[24:27], v[140:143], v[32:47]
    ds_read_b64_tr_b16 v[30:31], v9 offset:33568
    ds_read_b64_tr_b16 v[20:21], v9 offset:32864
    s_waitcnt lgkmcnt(1)
    v_mfma_f32_32x32x16_bf16 v[48:63], v[28:31], v[140:143], v[48:63]
    ds_read_b64_tr_b16 v[18:19], v9 offset:33600
    ds_read_b64_tr_b16 v[24:25], v9 offset:32896
    s_waitcnt lgkmcnt(1)
    v_mfma_f32_32x32x16_bf16 v[64:79], v[16:19], v[140:143], v[64:79]
    ds_read_b64_tr_b16 v[22:23], v9 offset:33632
    ds_read_b64_tr_b16 v[28:29], v9 offset:32928
    s_waitcnt lgkmcnt(1)
    v_mfma_f32_32x32x16_bf16 v[80:95], v[20:23], v[140:143], v[80:95]
    ds_read_b64_tr_b16 v[26:27], v9 offset:33664
    s_setprio 2
    v_readfirstlane_b32 s84, v3
    s_setprio 0
    s_cmp_ge_u32 s84, 4
    s_cbranch_scc0 L_spin_24
L_ok_23:
    ds_read_b64_tr_b16 v[16:17], v8 offset:6176
    s_waitcnt lgkmcnt(1)
    s_cbranch_vccnz L_sk_25
    v_mfma_f32_32x32x16_bf16 v[96:111], v[24:27], v[140:143], v[96:111]
L_sk_25:
    ds_read_b64_tr_b16 v[30:31], v9 offset:33696
    ds_read_b64_tr_b16 v[20:21], v8 offset:6208
    s_waitcnt lgkmcnt(1)
    s_cbranch_vccnz L_sk_26
    v_mfma_f32_32x32x16_bf16 v[112:127], v[28:31], v[140:143], v[112:127]
L_sk_26:
    ds_read_b64_tr_b16 v[18:19], v8 offset:6944
    ds_read_b64_tr_b16 v[24:25], v8 offset:6240
    s_waitcnt lgkmcnt(1)
    v_mfma_f32_32x32x16_bf16 v[32:47], v[16:19], v[144:147], v[32:47]
    ds_read_b64_tr_b16 v[22:23], v8 offset:6976
    ds_read_b64_tr_b16 v[28:29], v8 offset:6272
    s_add_u32 s81, s101, 3
    s_and_b32 s81, s81, 7
    s_lshl_b32 s81, s81, 2
    s_add_u32 s81, s81, s6
    s_mul_i32 s81, s81, 44032
    s_add_u32 m0, s78, 18528
    s_nop 0
    buffer_load_dwordx4 v10, s[52:55], s81 offen  lds
    s_waitcnt lgkmcnt(1)
    v_mfma_f32_32x32x16_bf16 v[48:63], v[20:23], v[144:147], v[48:63]
    ds_read_b64_tr_b16 v[26:27], v8 offset:7008
    ds_read_b64_tr_b16 v[16:17], v8 offset:6304
    s_waitcnt lgkmcnt(1)
    v_mfma_f32_32x32x16_bf16 v[64:79], v[24:27], v[144:147], v[64:79]
    ds_read_b64_tr_b16 v[30:31], v8 offset:7040
    ds_read_b64_tr_b16 v[20:21], v8 offset:6336
    s_add_u32 m0, s78, 19552
    s_nop 0
    buffer_load_dwordx4 v11, s[52:55], s81 offen  lds
    s_waitcnt lgkmcnt(1)
    v_mfma_f32_32x32x16_bf16 v[80:95], v[28:31], v[144:147], v[80:95]
    ds_read_b64_tr_b16 v[18:19], v8 offset:7072
    ds_read_b64_tr_b16 v[24:25], v8 offset:38944
    s_waitcnt lgkmcnt(1)
    s_cbranch_vccnz L_sk_27
    v_mfma_f32_32x32x16_bf16 v[96:111], v[16:19], v[144:147], v[96:111]
L_sk_27:
    ds_read_b64_tr_b16 v[22:23], v8 offset:7104
    ds_read_b64_tr_b16 v[28:29], v8 offset:38976
    s_add_u32 m0, s78, 20576
    s_nop 0
    buffer_load_dwordx4 v12, s[52:55], s81 offen  lds
    s_waitcnt lgkmcnt(1)
    s_cbranch_vccnz L_sk_28
    v_mfma_f32_32x32x16_bf16 v[112:127], v[20:23], v[144:147], v[112:127]
L_sk_28:
    ds_read_b64_tr_b16 v[26:27], v8 offset:39712
    ds_read_b64_tr_b16 v[16:17], v8 offset:39008
    s_waitcnt lgkmcnt(1)
    v_mfma_f32_32x32x16_bf16 v[32:47], v[24:27], v[148:151], v[32:47]
    ds_read_b64_tr_b16 v[30:31], v8 offset:39744
    ds_read_b64_tr_b16 v[20:21], v8 offset:39040
    s_add_u32 m0, s78, 21632
    s_nop 0
    buffer_load_dwordx4 v10, s[56:59], s81 offen  lds
    s_waitcnt lgkmcnt(1)
    v_mfma_f32_32x32x16_bf16 v[48:63], v[28:31], v[148:151], v[48:63]
    ds_read_b64_tr_b16 v[18:19], v8 offset:39776
    ds_read_b64_tr_b16 v[24:25], v8 offset:39072
    s_waitcnt lgkmcnt(1)
    v_mfma_f32_32x32x16_bf16 v[64:79], v[16:19], v[148:151], v[64:79]
    ds_read_b64_tr_b16 v[22:23], v8 offset:39808
    ds_read_b64_tr_b16 v[28:29], v8 offset:39104
    s_add_u32 m0, s78, 22656
    s_nop 0
    buffer_load_dwordx4 v11, s[56:59], s81 offen  lds
    s_waitcnt lgkmcnt(1)
    v_mfma_f32_32x32x16_bf16 v[80:95], v[20:23], v[148:151], v[80:95]
    ds_read_b64_tr_b16 v[26:27], v8 offset:39840
    ds_read_b64_tr_b16 v[16:17], v9 offset:6176
    s_waitcnt lgkmcnt(1)
    s_cbranch_vccnz L_sk_29
    v_mfma_f32_32x32x16_bf16 v[96:111], v[24:27], v[148:151], v[96:111]
L_sk_29:
    ds_read_b64_tr_b16 v[30:31], v8 offset:39872
    ds_read_b64_tr_b16 v[20:21], v9 offset:6208
    s_add_u32 m0, s78, 23680
    s_nop 0
    buffer_load_dwordx4 v12, s[56:59], s81 offen  lds
    s_waitcnt lgkmcnt(1)
    s_cbranch_vccnz L_sk_30
    v_mfma_f32_32x32x16_bf16 v[112:127], v[28:31], v[148:151], v[112:127]
L_sk_30:
    ds_read_b64_tr_b16 v[18:19], v9 offset:6944
    ds_read_b64_tr_b16 v[24:25], v9 offset:6240
    s_waitcnt vmcnt(6)
    ds_add_u32 v1, v2 offset:24
    s_waitcnt lgkmcnt(2)
    v_mfma_f32_32x32x16_bf16 v[32:47], v[16:19], v[152:155], v[32:47]
    ds_read_b64_tr_b16 v[22:23], v9 offset:6976
    ds_read_b64_tr_b16 v[28:29], v9 offset:6272
    s_waitcnt lgkmcnt(1)
    v_mfma_f32_32x32x16_bf16 v[48:63], v[20:23], v[152:155], v[48:63]
    ds_read_b64_tr_b16 v[26:27], v9 offset:7008
    ds_read_b64_tr_b16 v[16:17], v9 offset:6304
    s_waitcnt lgkmcnt(1)
    v_mfma_f32_32x32x16_bf16 v[64:79], v[24:27], v[152:155], v[64:79]
    ds_read_b64_tr_b16 v[30:31], v9 offset:7040
    ds_read_b64_tr_b16 v[20:21], v9 offset:6336
    s_waitcnt lgkmcnt(1)
    v_mfma_f32_32x32x16_bf16 v[80:95], v[28:31], v[152:155], v[80:95]
    ds_read_b64_tr_b16 v[18:19], v9 offset:7072
    ds_read_b64_tr_b16 v[24:25], v9 offset:38944
    s_waitcnt lgkmcnt(1)
    s_cbranch_vccnz L_sk_31
    v_mfma_f32_32x32x16_bf16 v[96:111], v[16:19], v[152:155], v[96:111]
L_sk_31:
    ds_read_b64_tr_b16 v[22:23], v9 offset:7104
    ds_read_b64_tr_b16 v[28:29], v9 offset:38976
    s_waitcnt lgkmcnt(1)
    s_cbranch_vccnz L_sk_32
    v_mfma_f32_32x32x16_bf16 v[112:127], v[20:23], v[152:155], v[112:127]
L_sk_32:
    ds_read_b64_tr_b16 v[26:27], v9 offset:39712
    ds_read_b64_tr_b16 v[16:17], v9 offset:39008
    ds_read_b32 v3, v1 offset:24
    s_waitcnt lgkmcnt(2)
    v_mfma_f32_32x32x16_bf16 v[32:47], v[24:27], v[156:159], v[32:47]
    ds_read_b64_tr_b16 v[30:31], v9 offset:39744
    ds_read_b64_tr_b16 v[20:21], v9 offset:39040
    s_waitcnt lgkmcnt(1)
    v_mfma_f32_32x32x16_bf16 v[48:63], v[28:31], v[156:159], v[48:63]
    ds_read_b64_tr_b16 v[18:19], v9 offset:39776
    ds_read_b64_tr_b16 v[24:25], v9 offset:39072
    s_waitcnt lgkmcnt(1)
    v_mfma_f32_32x32x16_bf16 v[64:79], v[16:19], v[156:159], v[64:79]
    ds_read_b64_tr_b16 v[22:23], v9 offset:39808
    ds_read_b64_tr_b16 v[28:29], v9 offset:39104
    s_waitcnt lgkmcnt(1)
    v_mfma_f32_32x32x16_bf16 v[80:95], v[20:23], v[156:159], v[80:95]
    ds_read_b64_tr_b16 v[26:27], v9 offset:39840
    s_setprio 2
    v_readfirstlane_b32 s84, v3
    s_setprio 0
    s_cmp_ge_u32 s84, 4
    s_cbranch_scc0 L_spin_34
L_ok_33:
    ds_read_b64_tr_b16 v[16:17], v8 offset:12352
    s_waitcnt lgkmcnt(1)
    s_cbranch_vccnz L_sk_35
    v_mfma_f32_32x32x16_bf16 v[96:111], v[24:27], v[156:159], v[96:111]
L_sk_35:
    ds_read_b64_tr_b16 v[30:31], v9 offset:39872
    ds_read_b64_tr_b16 v[20:21], v8 offset:12384
    s_add_u32 s81, s101, 4
    s_and_b32 s81, s81, 7
    s_lshl_b32 s81, s81, 2
    s_add_u32 s81, s81, s6
    s_mul_i32 s81, s81, 44032
    s_add_u32 m0, s78, 0
    s_nop 0
    buffer_load_dwordx4 v10, s[52:55], s81 offen  lds
    s_waitcnt lgkmcnt(1)
    s_cbranch_vccnz L_sk_36
    v_mfma_f32_32x32x16_bf16 v[112:127], v[28:31], v[156:159], v[112:127]
L_sk_36:
    ds_read_b64_tr_b16 v[18:19], v8 offset:13120
    ds_read_b64_tr_b16 v[24:25], v8 offset:12416
    s_waitcnt lgkmcnt(1)
    v_mfma_f32_32x32x16_bf16 v[32:47], v[16:19], v[160:163], v[32:47]
    ds_read_b64_tr_b16 v[22:23], v8 offset:13152
    ds_read_b64_tr_b16 v[28:29], v8 offset:12448
    s_add_u32 m0, s78, 1024
    s_nop 0
    buffer_load_dwordx4 v11, s[52:55], s81 offen  lds
    s_waitcnt lgkmcnt(1)
    v_mfma_f32_32x32x16_bf16 v[48:63], v[20:23], v[160:163], v[48:63]
    ds_read_b64_tr_b16 v[26:27], v8 offset:13184
    ds_read_b64_tr_b16 v[16:17], v8 offset:12480
    s_waitcnt lgkmcnt(1)
    v_mfma_f32_32x32x16_bf16 v[64:79], v[24:27], v[160:163], v[64:79]
    ds_read_b64_tr_b16 v[30:31], v8 offset:13216
    ds_read_b64_tr_b16 v[20:21], v8 offset:12512
    s_add_u32 m0, s78, 2048
    s_nop 0
    buffer_load_dwordx4 v12, s[52:55], s81 offen  lds
    s_waitcnt lgkmcnt(1)
    v_mfma_f32_32x32x16_bf16 v[80:95], v[28:31], v[160:163], v[80:95]
    ds_read_b64_tr_b16 v[18:19], v8 offset:13248
    ds_read_b64_tr_b16 v[24:25], v8 offset:45120
    s_waitcnt lgkmcnt(1)
    s_cbranch_vccnz L_sk_37
    v_mfma_f32_32x32x16_bf16 v[96:111], v[16:19], v[160:163], v[96:111]
L_sk_37:
    ds_read_b64_tr_b16 v[22:23], v8 offset:13280
    ds_read_b64_tr_b16 v[28:29], v8 offset:45152
    s_add_u32 m0, s78, 3104
    s_nop 0
    buffer_load_dwordx4 v10, s[56:59], s81 offen  lds
    s_waitcnt lgkmcnt(1)
    s_cbranch_vccnz L_sk_38
    v_mfma_f32_32x32x16_bf16 v[112:127], v[20:23], v[160:163], v[112:127]
L_sk_38:
    ds_read_b64_tr_b16 v[26:27], v8 offset:45888
    ds_read_b64_tr_b16 v[16:17], v8 offset:45184
    s_waitcnt lgkmcnt(1)
    v_mfma_f32_32x32x16_bf16 v[32:47], v[24:27], v[164:167], v[32:47]
    ds_read_b64_tr_b16 v[30:31], v8 offset:45920
    ds_read_b64_tr_b16 v[20:21], v8 offset:45216
    s_add_u32 m0, s78, 4128
    s_nop 0
    buffer_load_dwordx4 v11, s[56:59], s81 offen  lds
    s_waitcnt lgkmcnt(1)
    v_mfma_f32_32x32x16_bf16 v[48:63], v[28:31], v[164:167], v[48:63]
    ds_read_b64_tr_b16 v[18:19], v8 offset:45952
    ds_read_b64_tr_b16 v[24:25], v8 offset:45248
    s_waitcnt lgkmcnt(1)
    v_mfma_f32_32x32x16_bf16 v[64:79], v[16:19], v[164:167], v[64:79]
    ds_read_b64_tr_b16 v[22:23], v8 offset:45984
    ds_read_b64_tr_b16 v[28:29], v8 offset:45280
    s_add_u32 m0, s78, 5152
    s_nop 0
    buffer_load_dwordx4 v12, s[56:59], s81 offen  lds
    s_waitcnt lgkmcnt(1)
    v_mfma_f32_32x32x16_bf16 v[80:95], v[20:23], v[164:167], v[80:95]
    ds_read_b64_tr_b16 v[26:27], v8 offset:46016
    ds_read_b64_tr_b16 v[16:17], v9 offset:12352
    s_waitcnt lgkmcnt(1)
    s_cbranch_vccnz L_sk_39
    v_mfma_f32_32x32x16_bf16 v[96:111], v[24:27], v[164:167], v[96:111]
L_sk_39:
    ds_read_b64_tr_b16 v[30:31], v8 offset:46048
    ds_read_b64_tr_b16 v[20:21], v9 offset:12384
    s_waitcnt lgkmcnt(1)
    s_cbranch_vccnz L_sk_40
    v_mfma_f32_32x32x16_bf16 v[112:127], v[28:31], v[164:167], v[112:127]
L_sk_40:
    ds_read_b64_tr_b16 v[18:19], v9 offset:13120
    ds_read_b64_tr_b16 v[24:25], v9 offset:12416
    s_waitcnt vmcnt(6)
    ds_add_u32 v1, v2 offset:28
    s_waitcnt lgkmcnt(2)
    v_mfma_f32_32x32x16_bf16 v[32:47], v[16:19], v[168:171], v[32:47]
    ds_read_b64_tr_b16 v[22:23], v9 offset:13152
    ds_read_b64_tr_b16 v[28:29], v9 offset:12448
    s_waitcnt lgkmcnt(1)
    v_mfma_f32_32x32x16_bf16 v[48:63], v[20:23], v[168:171], v[48:63]
    ds_read_b64_tr_b16 v[26:27], v9 offset:13184
    ds_read_b64_tr_b16 v[16:17], v9 offset:12480
    s_waitcnt lgkmcnt(1)
    v_mfma_f32_32x32x16_bf16 v[64:79], v[24:27], v[168:171], v[64:79]
    ds_read_b64_tr_b16 v[30:31], v9 offset:13216
    ds_read_b64_tr_b16 v[20:21], v9 offset:12512
    s_waitcnt lgkmcnt(1)
    v_mfma_f32_32x32x16_bf16 v[80:95], v[28:31], v[168:171], v[80:95]
    ds_read_b64_tr_b16 v[18:19], v9 offset:13248
    ds_read_b64_tr_b16 v[24:25], v9 offset:45120
    s_waitcnt lgkmcnt(1)
    s_cbranch_vccnz L_sk_41
    v_mfma_f32_32x32x16_bf16 v[96:111], v[16:19], v[168:171], v[96:111]
L_sk_41:
    ds_read_b64_tr_b16 v[22:23], v9 offset:13280
    ds_read_b64_tr_b16 v[28:29], v9 offset:45152
    s_waitcnt lgkmcnt(1)
    s_cbranch_vccnz L_sk_42
    v_mfma_f32_32x32x16_bf16 v[112:127], v[20:23], v[168:171], v[112:127]
L_sk_42:
    ds_read_b64_tr_b16 v[26:27], v9 offset:45888
    ds_read_b64_tr_b16 v[16:17], v9 offset:45184
    ds_read_b32 v3, v1 offset:28
    s_waitcnt lgkmcnt(2)
    v_mfma_f32_32x32x16_bf16 v[32:47], v[24:27], v[172:175], v[32:47]
    ds_read_b64_tr_b16 v[30:31], v9 offset:45920
    ds_read_b64_tr_b16 v[20:21], v9 offset:45216
    s_waitcnt lgkmcnt(1)
    v_mfma_f32_32x32x16_bf16 v[48:63], v[28:31], v[172:175], v[48:63]
    ds_read_b64_tr_b16 v[18:19], v9 offset:45952
    ds_read_b64_tr_b16 v[24:25], v9 offset:45248
    s_waitcnt lgkmcnt(1)
    v_mfma_f32_32x32x16_bf16 v[64:79], v[16:19], v[172:175], v[64:79]
    ds_read_b64_tr_b16 v[22:23], v9 offset:45984
    ds_read_b64_tr_b16 v[28:29], v9 offset:45280
    s_waitcnt lgkmcnt(1)
    v_mfma_f32_32x32x16_bf16 v[80:95], v[20:23], v[172:175], v[80:95]
    ds_read_b64_tr_b16 v[26:27], v9 offset:46016
    s_setprio 2
    v_readfirstlane_b32 s84, v3
    s_setprio 0
    s_cmp_ge_u32 s84, 4
    s_cbranch_scc0 L_spin_44
L_ok_43:
    ds_read_b64_tr_b16 v[16:17], v8 offset:18528
    s_waitcnt lgkmcnt(1)
    s_cbranch_vccnz L_sk_45
    v_mfma_f32_32x32x16_bf16 v[96:111], v[24:27], v[172:175], v[96:111]
L_sk_45:
    ds_read_b64_tr_b16 v[30:31], v9 offset:46048
    ds_read_b64_tr_b16 v[20:21], v8 offset:18560
    s_add_u32 s81, s101, 5
    s_and_b32 s81, s81, 7
    s_lshl_b32 s81, s81, 2
    s_add_u32 s81, s81, s6
    s_mul_i32 s81, s81, 44032
    s_add_u32 m0, s78, 6176
    s_nop 0
    buffer_load_dwordx4 v10, s[52:55], s81 offen  lds
    s_waitcnt lgkmcnt(1)
    s_cbranch_vccnz L_sk_46
    v_mfma_f32_32x32x16_bf16 v[112:127], v[28:31], v[172:175], v[112:127]
L_sk_46:
    ds_read_b64_tr_b16 v[18:19], v8 offset:19296
    ds_read_b64_tr_b16 v[24:25], v8 offset:18592
    s_waitcnt lgkmcnt(1)
    v_mfma_f32_32x32x16_bf16 v[32:47], v[16:19], v[176:179], v[32:47]
    ds_read_b64_tr_b16 v[22:23], v8 offset:19328
    ds_read_b64_tr_b16 v[28:29], v8 offset:18624
    s_add_u32 m0, s78, 7200
    s_nop 0
    buffer_load_dwordx4 v11, s[52:55], s81 offen  lds
    s_waitcnt lgkmcnt(1)
    v_mfma_f32_32x32x16_bf16 v[48:63], v[20:23], v[176:179], v[48:63]
    ds_read_b64_tr_b16 v[26:27], v8 offset:19360
    ds_read_b64_tr_b16 v[16:17], v8 offset:18656
    s_waitcnt lgkmcnt(1)
    v_mfma_f32_32x32x16_bf16 v[64:79], v[24:27], v[176:179], v[64:79]
    ds_read_b64_tr_b16 v[30:31], v8 offset:19392
    ds_read_b64_tr_b16 v[20:21], v8 offset:18688
    s_add_u32 m0, s78, 8224
    s_nop 0
    buffer_load_dwordx4 v12, s[52:55], s81 offen  lds
    s_waitcnt lgkmcnt(1)
    v_mfma_f32_32x32x16_bf16 v[80:95], v[28:31], v[176:179], v[80:95]
    ds_read_b64_tr_b16 v[18:19], v8 offset:19424
    ds_read_b64_tr_b16 v[24:25], v8 offset:51296
    s_waitcnt lgkmcnt(1)
    s_cbranch_vccnz L_sk_47
    v_mfma_f32_32x32x16_bf16 v[96:111], v[16:19], v[176:179], v[96:111]
L_sk_47:
    ds_read_b64_tr_b16 v[22:23], v8 offset:19456
    ds_read_b64_tr_b16 v[28:29], v8 offset:51328
    s_add_u32 m0, s78, 9280
    s_nop 0
    buffer_load_dwordx4 v10, s[56:59], s81 offen  lds
    s_waitcnt lgkmcnt(1)
    s_cbranch_vccnz L_sk_48
    v_mfma_f32_32x32x16_bf16 v[112:127], v[20:23], v[176:179], v[112:127]
L_sk_48:
    ds_read_b64_tr_b16 v[26:27], v8 offset:52064
    ds_read_b64_tr_b16 v[16:17], v8 offset:51360
    ds_read_b32 v3, v1 offset:124
    s_waitcnt lgkmcnt(0)
    s_setprio 2
    v_readfirstlane_b32 s84, v3
    s_setprio 0
    s_cmp_ge_u32 s84, 4
    s_cbranch_scc0 L_spin_50
L_ok_49:
    s_lshl_b32 s80, s7, 7
    s_add_u32 s80, s80, 262144
    s_add_u32 m0, s78, 10304
    s_nop 0
    buffer_load_dwordx4 v11, s[56:59], s81 offen  lds
    s_add_u32 m0, s78, 11328
    s_nop 0
    buffer_load_dwordx4 v12, s[56:59], s81 offen  lds
    buffer_load_dword v14, v13, s[72:75], s80 offen sc1
    v_mfma_f32_32x32x16_bf16 v[32:47], v[24:27], v[180:183], v[32:47]
    ds_read_b64_tr_b16 v[30:31], v8 offset:52096
    ds_read_b64_tr_b16 v[20:21], v8 offset:51392
    s_waitcnt lgkmcnt(1)
    v_mfma_f32_32x32x16_bf16 v[48:63], v[28:31], v[180:183], v[48:63]
    ds_read_b64_tr_b16 v[18:19], v8 offset:52128
    ds_read_b64_tr_b16 v[24:25], v8 offset:51424
    s_waitcnt lgkmcnt(1)
    v_mfma_f32_32x32x16_bf16 v[64:79], v[16:19], v[180:183], v[64:79]
    ds_read_b64_tr_b16 v[22:23], v8 offset:52160
    ds_read_b64_tr_b16 v[28:29], v8 offset:51456
    s_waitcnt lgkmcnt(1)
    v_mfma_f32_32x32x16_bf16 v[80:95], v[20:23], v[180:183], v[80:95]
    ds_read_b64_tr_b16 v[26:27], v8 offset:52192
    ds_read_b64_tr_b16 v[16:17], v9 offset:18528
    s_waitcnt lgkmcnt(1)
    s_cbranch_vccnz L_sk_51
    v_mfma_f32_32x32x16_bf16 v[96:111], v[24:27], v[180:183], v[96:111]
L_sk_51:
    ds_read_b64_tr_b16 v[30:31], v8 offset:52224
    ds_read_b64_tr_b16 v[20:21], v9 offset:18560
    s_waitcnt lgkmcnt(1)
    s_cbranch_vccnz L_sk_52
    v_mfma_f32_32x32x16_bf16 v[112:127], v[28:31], v[180:183], v[112:127]
L_sk_52:
    ds_read_b64_tr_b16 v[18:19], v9 offset:19296
    ds_read_b64_tr_b16 v[24:25], v9 offset:18592
    s_waitcnt vmcnt(7)
    ds_add_u32 v1, v2 offset:32
    s_waitcnt lgkmcnt(2)
    v_mfma_f32_32x32x16_bf16 v[32:47], v[16:19], v[184:187], v[32:47]
    ds_read_b64_tr_b16 v[22:23], v9 offset:19328
    ds_read_b64_tr_b16 v[28:29], v9 offset:18624
    s_waitcnt lgkmcnt(1)
    v_mfma_f32_32x32x16_bf16 v[48:63], v[20:23], v[184:187], v[48:63]
    ds_read_b64_tr_b16 v[26:27], v9 offset:19360
    ds_read_b64_tr_b16 v[16:17], v9 offset:18656
    s_setprio 2
    v_bfe_u32 v3, v0, 4, 1
    v_lshlrev_b32 v3, 2, v3
    v_and_b32 v13, 7, v0
    v_xor_b32 v13, v13, v3
    v_lshlrev_b32 v13, 4, v13
    v_lshrrev_b32 v3, 3, v0
    v_lshl_add_u32 v13, v3, 10, v13
    s_and_b32 s79, s5, 7
    s_lshl_b32 s79, s79, 7
    v_add_u32 v13, s79, v13
    s_setprio 0
    s_mul_i32 s90, s6, 22
    s_cmp_eq_u32 s6, 3
    s_cselect_b32 s79, 1, 0
    s_sub_u32 s90, s90, s79
    s_lshr_b32 s79, s5, 3
    s_lshl_b32 s79, s79, 1
    s_lshl_b32 s89, s4, 2
    s_add_u32 s89, s89, s79
    s_mul_i32 s79, s101, 11
    s_lshr_b32 s79, s79, 2
    s_add_u32 s94, s90, s79
    s_mov_b32 s95, s94
    s_cmp_lt_u32 s6, 2
    s_cselect_b32 s79, 22, 21
    s_add_u32 s91, s90, s79
    s_waitcnt lgkmcnt(1)
    v_mfma_f32_32x32x16_bf16 v[64:79], v[24:27], v[184:187], v[64:79]
    ds_read_b64_tr_b16 v[30:31], v9 offset:19392
    ds_read_b64_tr_b16 v[20:21], v9 offset:18688
    s_waitcnt lgkmcnt(1)
    v_mfma_f32_32x32x16_bf16 v[80:95], v[28:31], v[184:187], v[80:95]
    ds_read_b64_tr_b16 v[18:19], v9 offset:19424
    ds_read_b64_tr_b16 v[24:25], v9 offset:51296
    s_waitcnt lgkmcnt(1)
    s_cbranch_vccnz L_sk_53
    v_mfma_f32_32x32x16_bf16 v[96:111], v[16:19], v[184:187], v[96:111]
L_sk_53:
    ds_read_b64_tr_b16 v[22:23], v9 offset:19456
    ds_read_b64_tr_b16 v[28:29], v9 offset:51328
    s_waitcnt lgkmcnt(1)
    s_cbranch_vccnz L_sk_54
    v_mfma_f32_32x32x16_bf16 v[112:127], v[20:23], v[184:187], v[112:127]
L_sk_54:
    ds_read_b64_tr_b16 v[26:27], v9 offset:52064
    ds_read_b64_tr_b16 v[16:17], v9 offset:51360
    ds_read_b32 v3, v1 offset:32
    s_waitcnt lgkmcnt(2)
    v_mfma_f32_32x32x16_bf16 v[32:47], v[24:27], v[188:191], v[32:47]
    ds_read_b64_tr_b16 v[30:31], v9 offset:52096
    ds_read_b64_tr_b16 v[20:21], v9 offset:51392
    s_waitcnt lgkmcnt(1)
    v_mfma_f32_32x32x16_bf16 v[48:63], v[28:31], v[188:191], v[48:63]
    ds_read_b64_tr_b16 v[18:19], v9 offset:52128
    ds_read_b64_tr_b16 v[24:25], v9 offset:51424
    s_waitcnt lgkmcnt(1)
    v_mfma_f32_32x32x16_bf16 v[64:79], v[16:19], v[188:191], v[64:79]
    ds_read_b64_tr_b16 v[22:23], v9 offset:52160
    ds_read_b64_tr_b16 v[28:29], v9 offset:51456
    s_waitcnt lgkmcnt(1)
    v_mfma_f32_32x32x16_bf16 v[80:95], v[20:23], v[188:191], v[80:95]
    ds_read_b64_tr_b16 v[26:27], v9 offset:52192
    s_setprio 2
    v_readfirstlane_b32 s84, v3
    s_setprio 0
    s_cmp_ge_u32 s84, 4
    s_cbranch_scc0 L_spin_56
L_ok_55:
    ds_read_b64_tr_b16 v[16:17], v8 offset:0
    s_waitcnt lgkmcnt(1)
    s_cbranch_vccnz L_sk_57
    v_mfma_f32_32x32x16_bf16 v[96:111], v[24:27], v[188:191], v[96:111]
L_sk_57:
    ds_read_b64_tr_b16 v[30:31], v9 offset:52224
    ds_read_b64_tr_b16 v[20:21], v8 offset:32
    s_add_u32 s81, s101, 6
    s_and_b32 s81, s81, 7
    s_lshl_b32 s81, s81, 2
    s_add_u32 s81, s81, s6
    s_mul_i32 s81, s81, 44032
    s_add_u32 m0, s78, 12352
    s_nop 0
    buffer_load_dwordx4 v10, s[52:55], s81 offen  lds
    s_waitcnt lgkmcnt(1)
    s_cbranch_vccnz L_sk_58
    v_mfma_f32_32x32x16_bf16 v[112:127], v[28:31], v[188:191], v[112:127]
L_sk_58:
    ds_read_b64_tr_b16 v[18:19], v8 offset:768
    ds_read_b64_tr_b16 v[24:25], v8 offset:64
    s_waitcnt lgkmcnt(1)
    v_mfma_f32_32x32x16_bf16 v[32:47], v[16:19], v[192:195], v[32:47]
    ds_read_b64_tr_b16 v[22:23], v8 offset:800
    ds_read_b64_tr_b16 v[28:29], v8 offset:96
    s_add_u32 m0, s78, 13376
    s_nop 0
    buffer_load_dwordx4 v11, s[52:55], s81 offen  lds
    s_waitcnt lgkmcnt(1)
    v_mfma_f32_32x32x16_bf16 v[48:63], v[20:23], v[192:195], v[48:63]
    ds_read_b64_tr_b16 v[26:27], v8 offset:832
    ds_read_b64_tr_b16 v[16:17], v8 offset:128
    s_waitcnt lgkmcnt(1)
    v_mfma_f32_32x32x16_bf16 v[64:79], v[24:27], v[192:195], v[64:79]
    ds_read_b64_tr_b16 v[30:31], v8 offset:864
    ds_read_b64_tr_b16 v[20:21], v8 offset:160
    s_add_u32 m0, s78, 14400
    s_nop 0
    buffer_load_dwordx4 v12, s[52:55], s81 offen  lds
    s_waitcnt lgkmcnt(1)
    v_mfma_f32_32x32x16_bf16 v[80:95], v[28:31], v[192:195], v[80:95]
    ds_read_b64_tr_b16 v[18:19], v8 offset:896
    ds_read_b64_tr_b16 v[24:25], v8 offset:32768
    s_waitcnt lgkmcnt(1)
    s_cbranch_vccnz L_sk_59
    v_mfma_f32_32x32x16_bf16 v[96:111], v[16:19], v[192:195], v[96:111]
L_sk_59:
    ds_read_b64_tr_b16 v[22:23], v8 offset:928
    ds_read_b64_tr_b16 v[28:29], v8 offset:32800
    s_add_u32 m0, s78, 15456
    s_nop 0
    buffer_load_dwordx4 v10, s[56:59], s81 offen  lds
    s_waitcnt lgkmcnt(1)
    s_cbranch_vccnz L_sk_60
    v_mfma_f32_32x32x16_bf16 v[112:127], v[20:23], v[192:195], v[112:127]
L_sk_60:
    ds_read_b64_tr_b16 v[26:27], v8 offset:33536
    ds_read_b64_tr_b16 v[16:17], v8 offset:32832
    s_waitcnt lgkmcnt(1)
    v_mfma_f32_32x32x16_bf16 v[32:47], v[24:27], v[196:199], v[32:47]
    ds_read_b64_tr_b16 v[30:31], v8 offset:33568
    ds_read_b64_tr_b16 v[20:21], v8 offset:32864
    s_add_u32 m0, s78, 16480
    s_nop 0
    buffer_load_dwordx4 v11, s[56:59], s81 offen  lds
    s_waitcnt lgkmcnt(1)
    v_mfma_f32_32x32x16_bf16 v[48:63], v[28:31], v[196:199], v[48:63]
    ds_read_b64_tr_b16 v[18:19], v8 offset:33600
    ds_read_b64_tr_b16 v[24:25], v8 offset:32896
    s_waitcnt lgkmcnt(1)
    v_mfma_f32_32x32x16_bf16 v[64:79], v[16:19], v[196:199], v[64:79]
    ds_read_b64_tr_b16 v[22:23], v8 offset:33632
    ds_read_b64_tr_b16 v[28:29], v8 offset:32928
    s_add_u32 m0, s78, 17504
    s_nop 0
    buffer_load_dwordx4 v12, s[56:59], s81 offen  lds
    s_waitcnt lgkmcnt(1)
    v_mfma_f32_32x32x16_bf16 v[80:95], v[20:23], v[196:199], v[80:95]
    ds_read_b64_tr_b16 v[26:27], v8 offset:33664
    ds_read_b64_tr_b16 v[16:17], v9 offset:0
    s_waitcnt lgkmcnt(1)
    s_cbranch_vccnz L_sk_61
    v_mfma_f32_32x32x16_bf16 v[96:111], v[24:27], v[196:199], v[96:111]
L_sk_61:
    ds_read_b64_tr_b16 v[30:31], v8 offset:33696
    ds_read_b64_tr_b16 v[20:21], v9 offset:32
    s_waitcnt lgkmcnt(1)
    s_cbranch_vccnz L_sk_62
    v_mfma_f32_32x32x16_bf16 v[112:127], v[28:31], v[196:199], v[112:127]
L_sk_62:
    ds_read_b64_tr_b16 v[18:19], v9 offset:768
    ds_read_b64_tr_b16 v[24:25], v9 offset:64
    s_waitcnt vmcnt(7)
    ds_add_u32 v1, v2 offset:36
    s_waitcnt lgkmcnt(2)
    v_mfma_f32_32x32x16_bf16 v[32:47], v[16:19], v[200:203], v[32:47]
    ds_read_b64_tr_b16 v[22:23], v9 offset:800
    ds_read_b64_tr_b16 v[28:29], v9 offset:96
    s_waitcnt lgkmcnt(1)
    v_mfma_f32_32x32x16_bf16 v[48:63], v[20:23], v[200:203], v[48:63]
    ds_read_b64_tr_b16 v[26:27], v9 offset:832
    ds_read_b64_tr_b16 v[16:17], v9 offset:128
    s_waitcnt lgkmcnt(1)
    v_mfma_f32_32x32x16_bf16 v[64:79], v[24:27], v[200:203], v[64:79]
    ds_read_b64_tr_b16 v[30:31], v9 offset:864
    ds_read_b64_tr_b16 v[20:21], v9 offset:160
    s_waitcnt lgkmcnt(1)
    v_mfma_f32_32x32x16_bf16 v[80:95], v[28:31], v[200:203], v[80:95]
    ds_read_b64_tr_b16 v[18:19], v9 offset:896
    ds_read_b64_tr_b16 v[24:25], v9 offset:32768
    s_waitcnt lgkmcnt(1)
    s_cbranch_vccnz L_sk_63
    v_mfma_f32_32x32x16_bf16 v[96:111], v[16:19], v[200:203], v[96:111]
L_sk_63:
    ds_read_b64_tr_b16 v[22:23], v9 offset:928
    ds_read_b64_tr_b16 v[28:29], v9 offset:32800
    s_waitcnt lgkmcnt(1)
    s_cbranch_vccnz L_sk_64
    v_mfma_f32_32x32x16_bf16 v[112:127], v[20:23], v[200:203], v[112:127]
L_sk_64:
    ds_read_b64_tr_b16 v[26:27], v9 offset:33536
    ds_read_b64_tr_b16 v[16:17], v9 offset:32832
    ds_read_b32 v3, v1 offset:36
    s_waitcnt lgkmcnt(2)
    v_mfma_f32_32x32x16_bf16 v[32:47], v[24:27], v[204:207], v[32:47]
    ds_read_b64_tr_b16 v[30:31], v9 offset:33568
    ds_read_b64_tr_b16 v[20:21], v9 offset:32864
    s_waitcnt lgkmcnt(1)
    v_mfma_f32_32x32x16_bf16 v[48:63], v[28:31], v[204:207], v[48:63]
    ds_read_b64_tr_b16 v[18:19], v9 offset:33600
    ds_read_b64_tr_b16 v[24:25], v9 offset:32896
    s_waitcnt lgkmcnt(1)
    v_mfma_f32_32x32x16_bf16 v[64:79], v[16:19], v[204:207], v[64:79]
    ds_read_b64_tr_b16 v[22:23], v9 offset:33632
    ds_read_b64_tr_b16 v[28:29], v9 offset:32928
    s_waitcnt lgkmcnt(1)
    v_mfma_f32_32x32x16_bf16 v[80:95], v[20:23], v[204:207], v[80:95]
    ds_read_b64_tr_b16 v[26:27], v9 offset:33664
    s_setprio 2
    v_readfirstlane_b32 s84, v3
    s_setprio 0
    s_cmp_ge_u32 s84, 4
    s_cbranch_scc0 L_spin_66
L_ok_65:
    ds_read_b64_tr_b16 v[16:17], v8 offset:6176
    s_waitcnt lgkmcnt(1)
    s_cbranch_vccnz L_sk_67
    v_mfma_f32_32x32x16_bf16 v[96:111], v[24:27], v[204:207], v[96:111]
L_sk_67:
    ds_read_b64_tr_b16 v[30:31], v9 offset:33696
    ds_read_b64_tr_b16 v[20:21], v8 offset:6208
    s_add_u32 s81, s101, 7
    s_and_b32 s81, s81, 7
    s_lshl_b32 s81, s81, 2
    s_add_u32 s81, s81, s6
    s_mul_i32 s81, s81, 44032
    s_add_u32 m0, s78, 18528
    s_nop 0
    buffer_load_dwordx4 v10, s[52:55], s81 offen  lds
    s_waitcnt lgkmcnt(1)
    s_cbranch_vccnz L_sk_68
    v_mfma_f32_32x32x16_bf16 v[112:127], v[28:31], v[204:207], v[112:127]
L_sk_68:
    ds_read_b64_tr_b16 v[18:19], v8 offset:6944
    ds_read_b64_tr_b16 v[24:25], v8 offset:6240
    s_waitcnt lgkmcnt(1)
    v_mfma_f32_32x32x16_bf16 v[32:47], v[16:19], v[208:211], v[32:47]
    ds_read_b64_tr_b16 v[22:23], v8 offset:6976
    ds_read_b64_tr_b16 v[28:29], v8 offset:6272
    s_add_u32 m0, s78, 19552
    s_nop 0
    buffer_load_dwordx4 v11, s[52:55], s81 offen  lds
    s_waitcnt lgkmcnt(1)
    v_mfma_f32_32x32x16_bf16 v[48:63], v[20:23], v[208:211], v[48:63]
    ds_read_b64_tr_b16 v[26:27], v8 offset:7008
    ds_read_b64_tr_b16 v[16:17], v8 offset:6304
    s_waitcnt lgkmcnt(1)
    v_mfma_f32_32x32x16_bf16 v[64:79], v[24:27], v[208:211], v[64:79]
    ds_read_b64_tr_b16 v[30:31], v8 offset:7040
    ds_read_b64_tr_b16 v[20:21], v8 offset:6336
    s_add_u32 m0, s78, 20576
    s_nop 0
    buffer_load_dwordx4 v12, s[52:55], s81 offen  lds
    s_waitcnt lgkmcnt(1)
    v_mfma_f32_32x32x16_bf16 v[80:95], v[28:31], v[208:211], v[80:95]
    ds_read_b64_tr_b16 v[18:19], v8 offset:7072
    ds_read_b64_tr_b16 v[24:25], v8 offset:38944
    s_waitcnt lgkmcnt(1)
    s_cbranch_vccnz L_sk_69
    v_mfma_f32_32x32x16_bf16 v[96:111], v[16:19], v[208:211], v[96:111]
L_sk_69:
    ds_read_b64_tr_b16 v[22:23], v8 offset:7104
    ds_read_b64_tr_b16 v[28:29], v8 offset:38976
    s_add_u32 m0, s78, 21632
    s_nop 0
    buffer_load_dwordx4 v10, s[56:59], s81 offen  lds
    s_waitcnt lgkmcnt(1)
    s_cbranch_vccnz L_sk_70
    v_mfma_f32_32x32x16_bf16 v[112:127], v[20:23], v[208:211], v[112:127]
L_sk_70:
    ds_read_b64_tr_b16 v[26:27], v8 offset:39712
    ds_read_b64_tr_b16 v[16:17], v8 offset:39008
    s_waitcnt lgkmcnt(1)
    v_mfma_f32_32x32x16_bf16 v[32:47], v[24:27], v[212:215], v[32:47]
    ds_read_b64_tr_b16 v[30:31], v8 offset:39744
    ds_read_b64_tr_b16 v[20:21], v8 offset:39040
    s_add_u32 m0, s78, 22656
    s_nop 0
    buffer_load_dwordx4 v11, s[56:59], s81 offen  lds
    s_waitcnt lgkmcnt(1)
    v_mfma_f32_32x32x16_bf16 v[48:63], v[28:31], v[212:215], v[48:63]
    ds_read_b64_tr_b16 v[18:19], v8 offset:39776
    ds_read_b64_tr_b16 v[24:25], v8 offset:39072
    s_waitcnt lgkmcnt(1)
    v_mfma_f32_32x32x16_bf16 v[64:79], v[16:19], v[212:215], v[64:79]
    ds_read_b64_tr_b16 v[22:23], v8 offset:39808
    ds_read_b64_tr_b16 v[28:29], v8 offset:39104
    s_add_u32 m0, s78, 23680
    s_nop 0
    buffer_load_dwordx4 v12, s[56:59], s81 offen  lds
    s_waitcnt lgkmcnt(1)
    v_mfma_f32_32x32x16_bf16 v[80:95], v[20:23], v[212:215], v[80:95]
    ds_read_b64_tr_b16 v[26:27], v8 offset:39840
    ds_read_b64_tr_b16 v[16:17], v9 offset:6176
    s_waitcnt lgkmcnt(1)
    s_cbranch_vccnz L_sk_71
    v_mfma_f32_32x32x16_bf16 v[96:111], v[24:27], v[212:215], v[96:111]
L_sk_71:
    ds_read_b64_tr_b16 v[30:31], v8 offset:39872
    ds_read_b64_tr_b16 v[20:21], v9 offset:6208
    s_waitcnt lgkmcnt(1)
    s_cbranch_vccnz L_sk_72
    v_mfma_f32_32x32x16_bf16 v[112:127], v[28:31], v[212:215], v[112:127]
L_sk_72:
    ds_read_b64_tr_b16 v[18:19], v9 offset:6944
    ds_read_b64_tr_b16 v[24:25], v9 offset:6240
    s_waitcnt vmcnt(6)
    ds_add_u32 v1, v2 offset:40
    s_waitcnt lgkmcnt(2)
    v_mfma_f32_32x32x16_bf16 v[32:47], v[16:19], v[216:219], v[32:47]
    ds_read_b64_tr_b16 v[22:23], v9 offset:6976
    ds_read_b64_tr_b16 v[28:29], v9 offset:6272
    s_waitcnt lgkmcnt(1)
    v_mfma_f32_32x32x16_bf16 v[48:63], v[20:23], v[216:219], v[48:63]
    ds_read_b64_tr_b16 v[26:27], v9 offset:7008
    ds_read_b64_tr_b16 v[16:17], v9 offset:6304
    s_waitcnt lgkmcnt(1)
    v_mfma_f32_32x32x16_bf16 v[64:79], v[24:27], v[216:219], v[64:79]
    ds_read_b64_tr_b16 v[30:31], v9 offset:7040
    ds_read_b64_tr_b16 v[20:21], v9 offset:6336
    s_lshl_b32 s80, s94, 14
    s_add_u32 s94, s94, 1
    s_cmp_eq_u32 s94, s91
    s_cselect_b32 s94, s90, s94
    s_add_u32 m0, s78, 26784
    s_add_u32 s81, s80, 0
    buffer_load_dwordx4 v13, s[60:63], s81 offen  lds
    s_waitcnt lgkmcnt(1)
    v_mfma_f32_32x32x16_bf16 v[80:95], v[28:31], v[216:219], v[80:95]
    ds_read_b64_tr_b16 v[18:19], v9 offset:7072
    ds_read_b64_tr_b16 v[24:25], v9 offset:38944
    s_waitcnt lgkmcnt(1)
    s_cbranch_vccnz L_sk_73
    v_mfma_f32_32x32x16_bf16 v[96:111], v[16:19], v[216:219], v[96:111]
L_sk_73:
    ds_read_b64_tr_b16 v[22:23], v9 offset:7104
    ds_read_b64_tr_b16 v[28:29], v9 offset:38976
    s_add_u32 m0, s78, 27808
    s_add_u32 s81, s80, 8192
    buffer_load_dwordx4 v13, s[60:63], s81 offen  lds
    s_waitcnt lgkmcnt(1)
    s_cbranch_vccnz L_sk_74
    v_mfma_f32_32x32x16_bf16 v[112:127], v[20:23], v[216:219], v[112:127]
L_sk_74:
    ds_read_b64_tr_b16 v[26:27], v9 offset:39712
    ds_read_b64_tr_b16 v[16:17], v9 offset:39008
    ds_read_b32 v3, v1 offset:40
    s_waitcnt lgkmcnt(2)
    v_mfma_f32_32x32x16_bf16 v[32:47], v[24:27], v[220:223], v[32:47]
    ds_read_b64_tr_b16 v[30:31], v9 offset:39744
    ds_read_b64_tr_b16 v[20:21], v9 offset:39040
    s_lshl_b32 s80, s94, 14
    s_add_u32 s94, s94, 1
    s_cmp_eq_u32 s94, s91
    s_cselect_b32 s94, s90, s94
    s_add_u32 m0, s78, 28832
    s_add_u32 s81, s80, 0
    buffer_load_dwordx4 v13, s[60:63], s81 offen  lds
    s_waitcnt lgkmcnt(1)
    v_mfma_f32_32x32x16_bf16 v[48:63], v[28:31], v[220:223], v[48:63]
    ds_read_b64_tr_b16 v[18:19], v9 offset:39776
    ds_read_b64_tr_b16 v[24:25], v9 offset:39072
    s_waitcnt lgkmcnt(1)
    v_mfma_f32_32x32x16_bf16 v[64:79], v[16:19], v[220:223], v[64:79]
    ds_read_b64_tr_b16 v[22:23], v9 offset:39808
    ds_read_b64_tr_b16 v[28:29], v9 offset:39104
    s_add_u32 m0, s78, 29856
    s_add_u32 s81, s80, 8192
    buffer_load_dwordx4 v13, s[60:63], s81 offen  lds
    s_waitcnt lgkmcnt(1)
    v_mfma_f32_32x32x16_bf16 v[80:95], v[20:23], v[220:223], v[80:95]
    ds_read_b64_tr_b16 v[26:27], v9 offset:39840
    s_setprio 2
    v_readfirstlane_b32 s84, v3
    s_setprio 0
    s_cmp_ge_u32 s84, 4
    s_cbranch_scc0 L_spin_76
L_ok_75:
    ds_read_b64_tr_b16 v[16:17], v8 offset:12352
    s_waitcnt lgkmcnt(1)
    s_cbranch_vccnz L_sk_77
    v_mfma_f32_32x32x16_bf16 v[96:111], v[24:27], v[220:223], v[96:111]
L_sk_77:
    ds_read_b64_tr_b16 v[30:31], v9 offset:39872
    ds_read_b64_tr_b16 v[20:21], v8 offset:12384
    s_lshl_b32 s80, s94, 14
    s_add_u32 s94, s94, 1
    s_cmp_eq_u32 s94, s91
    s_cselect_b32 s94, s90, s94
    s_add_u32 m0, s78, 0
    s_add_u32 s81, s80, 0
    buffer_load_dwordx4 v13, s[60:63], s81 offen  lds
    s_waitcnt lgkmcnt(1)
    s_cbranch_vccnz L_sk_78
    v_mfma_f32_32x32x16_bf16 v[112:127], v[28:31], v[220:223], v[112:127]
L_sk_78:
    ds_read_b64_tr_b16 v[18:19], v8 offset:13120
    ds_read_b64_tr_b16 v[24:25], v8 offset:12416
    s_waitcnt lgkmcnt(1)
    v_mfma_f32_32x32x16_bf16 v[32:47], v[16:19], v[224:227], v[32:47]
    ds_read_b64_tr_b16 v[22:23], v8 offset:13152
    ds_read_b64_tr_b16 v[28:29], v8 offset:12448
    s_add_u32 m0, s78, 1024
    s_add_u32 s81, s80, 8192
    buffer_load_dwordx4 v13, s[60:63], s81 offen  lds
    s_waitcnt lgkmcnt(1)
    v_mfma_f32_32x32x16_bf16 v[48:63], v[20:23], v[224:227], v[48:63]
    ds_read_b64_tr_b16 v[26:27], v8 offset:13184
    ds_read_b64_tr_b16 v[16:17], v8 offset:12480
    s_waitcnt lgkmcnt(1)
    v_mfma_f32_32x32x16_bf16 v[64:79], v[24:27], v[224:227], v[64:79]
    ds_read_b64_tr_b16 v[30:31], v8 offset:13216
    ds_read_b64_tr_b16 v[20:21], v8 offset:12512
    s_lshl_b32 s80, s94, 14
    s_add_u32 s94, s94, 1
    s_cmp_eq_u32 s94, s91
    s_cselect_b32 s94, s90, s94
    s_add_u32 m0, s78, 2048
    s_add_u32 s81, s80, 0
    buffer_load_dwordx4 v13, s[60:63], s81 offen  lds
    s_waitcnt lgkmcnt(1)
    v_mfma_f32_32x32x16_bf16 v[80:95], v[28:31], v[224:227], v[80:95]
    ds_read_b64_tr_b16 v[18:19], v8 offset:13248
    ds_read_b64_tr_b16 v[24:25], v8 offset:45120
    s_waitcnt lgkmcnt(1)
    s_cbranch_vccnz L_sk_79
    v_mfma_f32_32x32x16_bf16 v[96:111], v[16:19], v[224:227], v[96:111]
L_sk_79:
    ds_read_b64_tr_b16 v[22:23], v8 offset:13280
    ds_read_b64_tr_b16 v[28:29], v8 offset:45152
    s_add_u32 m0, s78, 3072
    s_add_u32 s81, s80, 8192
    buffer_load_dwordx4 v13, s[60:63], s81 offen  lds
    s_waitcnt lgkmcnt(1)
    s_cbranch_vccnz L_sk_80
    v_mfma_f32_32x32x16_bf16 v[112:127], v[20:23], v[224:227], v[112:127]
L_sk_80:
    ds_read_b64_tr_b16 v[26:27], v8 offset:45888
    ds_read_b64_tr_b16 v[16:17], v8 offset:45184
    s_waitcnt lgkmcnt(1)
    v_mfma_f32_32x32x16_bf16 v[32:47], v[24:27], v[228:231], v[32:47]
    ds_read_b64_tr_b16 v[30:31], v8 offset:45920
    ds_read_b64_tr_b16 v[20:21], v8 offset:45216
    s_lshl_b32 s80, s94, 14
    s_add_u32 s94, s94, 1
    s_cmp_eq_u32 s94, s91
    s_cselect_b32 s94, s90, s94
    s_add_u32 m0, s78, 4096
    s_add_u32 s81, s80, 0
    buffer_load_dwordx4 v13, s[60:63], s81 offen  lds
    s_waitcnt lgkmcnt(1)
    v_mfma_f32_32x32x16_bf16 v[48:63], v[28:31], v[228:231], v[48:63]
    ds_read_b64_tr_b16 v[18:19], v8 offset:45952
    ds_read_b64_tr_b16 v[24:25], v8 offset:45248
    s_waitcnt lgkmcnt(1)
    v_mfma_f32_32x32x16_bf16 v[64:79], v[16:19], v[228:231], v[64:79]
    ds_read_b64_tr_b16 v[22:23], v8 offset:45984
    ds_read_b64_tr_b16 v[28:29], v8 offset:45280
    s_add_u32 m0, s78, 5120
    s_add_u32 s81, s80, 8192
    buffer_load_dwordx4 v13, s[60:63], s81 offen  lds
    s_waitcnt lgkmcnt(1)
    v_mfma_f32_32x32x16_bf16 v[80:95], v[20:23], v[228:231], v[80:95]
    ds_read_b64_tr_b16 v[26:27], v8 offset:46016
    ds_read_b64_tr_b16 v[16:17], v9 offset:12352
    s_waitcnt lgkmcnt(1)
    s_cbranch_vccnz L_sk_81
    v_mfma_f32_32x32x16_bf16 v[96:111], v[24:27], v[228:231], v[96:111]
L_sk_81:
    ds_read_b64_tr_b16 v[30:31], v8 offset:46048
    ds_read_b64_tr_b16 v[20:21], v9 offset:12384
    s_waitcnt lgkmcnt(1)
    s_cbranch_vccnz L_sk_82
    v_mfma_f32_32x32x16_bf16 v[112:127], v[28:31], v[228:231], v[112:127]
L_sk_82:
    ds_read_b64_tr_b16 v[18:19], v9 offset:13120
    ds_read_b64_tr_b16 v[24:25], v9 offset:12416
    s_waitcnt vmcnt(10)
    ds_add_u32 v1, v2 offset:44
    s_waitcnt lgkmcnt(2)
    v_mfma_f32_32x32x16_bf16 v[32:47], v[16:19], v[232:235], v[32:47]
    ds_read_b64_tr_b16 v[22:23], v9 offset:13152
    ds_read_b64_tr_b16 v[28:29], v9 offset:12448
    s_waitcnt lgkmcnt(1)
    v_mfma_f32_32x32x16_bf16 v[48:63], v[20:23], v[232:235], v[48:63]
    ds_read_b64_tr_b16 v[26:27], v9 offset:13184
    ds_read_b64_tr_b16 v[16:17], v9 offset:12480
    s_waitcnt lgkmcnt(1)
    v_mfma_f32_32x32x16_bf16 v[64:79], v[24:27], v[232:235], v[64:79]
    ds_read_b64_tr_b16 v[30:31], v9 offset:13216
    ds_read_b64_tr_b16 v[20:21], v9 offset:12512
    s_waitcnt lgkmcnt(1)
    v_mfma_f32_32x32x16_bf16 v[80:95], v[28:31], v[232:235], v[80:95]
    ds_read_b64_tr_b16 v[18:19], v9 offset:13248
    ds_read_b64_tr_b16 v[24:25], v9 offset:45120
    s_waitcnt lgkmcnt(1)
    s_cbranch_vccnz L_sk_83
    v_mfma_f32_32x32x16_bf16 v[96:111], v[16:19], v[232:235], v[96:111]
L_sk_83:
    ds_read_b64_tr_b16 v[22:23], v9 offset:13280
    ds_read_b64_tr_b16 v[28:29], v9 offset:45152
    s_waitcnt lgkmcnt(1)
    s_cbranch_vccnz L_sk_84
    v_mfma_f32_32x32x16_bf16 v[112:127], v[20:23], v[232:235], v[112:127]
L_sk_84:
    ds_read_b64_tr_b16 v[26:27], v9 offset:45888
    ds_read_b64_tr_b16 v[16:17], v9 offset:45184
    ds_read_b32 v3, v1 offset:44
    s_waitcnt lgkmcnt(2)
    v_mfma_f32_32x32x16_bf16 v[32:47], v[24:27], v[236:239], v[32:47]
    ds_read_b64_tr_b16 v[30:31], v9 offset:45920
    ds_read_b64_tr_b16 v[20:21], v9 offset:45216
    s_waitcnt lgkmcnt(1)
    v_mfma_f32_32x32x16_bf16 v[48:63], v[28:31], v[236:239], v[48:63]
    ds_read_b64_tr_b16 v[18:19], v9 offset:45952
    ds_read_b64_tr_b16 v[24:25], v9 offset:45248
    s_waitcnt lgkmcnt(1)
    v_mfma_f32_32x32x16_bf16 v[64:79], v[16:19], v[236:239], v[64:79]
    ds_read_b64_tr_b16 v[22:23], v9 offset:45984
    ds_read_b64_tr_b16 v[28:29], v9 offset:45280
    s_waitcnt lgkmcnt(1)
    v_mfma_f32_32x32x16_bf16 v[80:95], v[20:23], v[236:239], v[80:95]
    ds_read_b64_tr_b16 v[26:27], v9 offset:46016
    s_setprio 2
    v_readfirstlane_b32 s84, v3
    s_setprio 0
    s_cmp_ge_u32 s84, 4
    s_cbranch_scc0 L_spin_86
L_ok_85:
    ds_read_b64_tr_b16 v[16:17], v8 offset:18528
    s_waitcnt lgkmcnt(1)
    s_cbranch_vccnz L_sk_87
    v_mfma_f32_32x32x16_bf16 v[96:111], v[24:27], v[236:239], v[96:111]
L_sk_87:
    ds_read_b64_tr_b16 v[30:31], v9 offset:46048
    ds_read_b64_tr_b16 v[20:21], v8 offset:18560
    s_lshl_b32 s80, s94, 14
    s_add_u32 s94, s94, 1
    s_cmp_eq_u32 s94, s91
    s_cselect_b32 s94, s90, s94
    s_add_u32 m0, s78, 6144
    s_add_u32 s81, s80, 0
    buffer_load_dwordx4 v13, s[60:63], s81 offen  lds
    s_waitcnt lgkmcnt(1)
    s_cbranch_vccnz L_sk_88
    v_mfma_f32_32x32x16_bf16 v[112:127], v[28:31], v[236:239], v[112:127]
L_sk_88:
    ds_read_b64_tr_b16 v[18:19], v8 offset:19296
    ds_read_b64_tr_b16 v[24:25], v8 offset:18592
    s_waitcnt lgkmcnt(1)
    v_mfma_f32_32x32x16_bf16 v[32:47], v[16:19], v[240:243], v[32:47]
    ds_read_b64_tr_b16 v[22:23], v8 offset:19328
    ds_read_b64_tr_b16 v[28:29], v8 offset:18624
    s_add_u32 m0, s78, 7168
    s_add_u32 s81, s80, 8192
    buffer_load_dwordx4 v13, s[60:63], s81 offen  lds
    s_waitcnt lgkmcnt(1)
    v_mfma_f32_32x32x16_bf16 v[48:63], v[20:23], v[240:243], v[48:63]
    ds_read_b64_tr_b16 v[26:27], v8 offset:19360
    ds_read_b64_tr_b16 v[16:17], v8 offset:18656
    s_waitcnt lgkmcnt(1)
    v_mfma_f32_32x32x16_bf16 v[64:79], v[24:27], v[240:243], v[64:79]
    ds_read_b64_tr_b16 v[30:31], v8 offset:19392
    ds_read_b64_tr_b16 v[20:21], v8 offset:18688
    s_lshl_b32 s80, s94, 14
    s_add_u32 s94, s94, 1
    s_cmp_eq_u32 s94, s91
    s_cselect_b32 s94, s90, s94
    s_add_u32 m0, s78, 8192
    s_add_u32 s81, s80, 0
    buffer_load_dwordx4 v13, s[60:63], s81 offen  lds
    s_waitcnt lgkmcnt(1)
    v_mfma_f32_32x32x16_bf16 v[80:95], v[28:31], v[240:243], v[80:95]
    ds_read_b64_tr_b16 v[18:19], v8 offset:19424
    ds_read_b64_tr_b16 v[24:25], v8 offset:51296
    s_waitcnt lgkmcnt(1)
    s_cbranch_vccnz L_sk_89
    v_mfma_f32_32x32x16_bf16 v[96:111], v[16:19], v[240:243], v[96:111]
L_sk_89:
    ds_read_b64_tr_b16 v[22:23], v8 offset:19456
    ds_read_b64_tr_b16 v[28:29], v8 offset:51328
    s_add_u32 m0, s78, 9216
    s_add_u32 s81, s80, 8192
    buffer_load_dwordx4 v13, s[60:63], s81 offen  lds
    s_waitcnt lgkmcnt(1)
    s_cbranch_vccnz L_sk_90
    v_mfma_f32_32x32x16_bf16 v[112:127], v[20:23], v[240:243], v[112:127]
L_sk_90:
    ds_read_b64_tr_b16 v[26:27], v8 offset:52064
    ds_read_b64_tr_b16 v[16:17], v8 offset:51360
    s_waitcnt lgkmcnt(1)
    v_mfma_f32_32x32x16_bf16 v[32:47], v[24:27], v[244:247], v[32:47]
    ds_read_b64_tr_b16 v[30:31], v8 offset:52096
    ds_read_b64_tr_b16 v[20:21], v8 offset:51392
    s_lshl_b32 s80, s94, 14
    s_add_u32 s94, s94, 1
    s_cmp_eq_u32 s94, s91
    s_cselect_b32 s94, s90, s94
    s_add_u32 m0, s78, 10240
    s_add_u32 s81, s80, 0
    buffer_load_dwordx4 v13, s[60:63], s81 offen  lds
    s_waitcnt lgkmcnt(1)
    v_mfma_f32_32x32x16_bf16 v[48:63], v[28:31], v[244:247], v[48:63]
    ds_read_b64_tr_b16 v[18:19], v8 offset:52128
    ds_read_b64_tr_b16 v[24:25], v8 offset:51424
    s_waitcnt lgkmcnt(1)
    v_mfma_f32_32x32x16_bf16 v[64:79], v[16:19], v[244:247], v[64:79]
    ds_read_b64_tr_b16 v[22:23], v8 offset:52160
    ds_read_b64_tr_b16 v[28:29], v8 offset:51456
    s_add_u32 m0, s78, 11264
    s_add_u32 s81, s80, 8192
    buffer_load_dwordx4 v13, s[60:63], s81 offen  lds
    s_waitcnt lgkmcnt(1)
    v_mfma_f32_32x32x16_bf16 v[80:95], v[20:23], v[244:247], v[80:95]
    ds_read_b64_tr_b16 v[26:27], v8 offset:52192
    ds_read_b64_tr_b16 v[16:17], v9 offset:18528
    s_waitcnt lgkmcnt(1)
    s_cbranch_vccnz L_sk_91
    v_mfma_f32_32x32x16_bf16 v[96:111], v[24:27], v[244:247], v[96:111]
L_sk_91:
    ds_read_b64_tr_b16 v[30:31], v8 offset:52224
    ds_read_b64_tr_b16 v[20:21], v9 offset:18560
    s_waitcnt lgkmcnt(1)
    s_cbranch_vccnz L_sk_92
    v_mfma_f32_32x32x16_bf16 v[112:127], v[28:31], v[244:247], v[112:127]
L_sk_92:
    ds_read_b64_tr_b16 v[18:19], v9 offset:19296
    ds_read_b64_tr_b16 v[24:25], v9 offset:18592
    s_waitcnt lgkmcnt(1)
    v_mfma_f32_32x32x16_bf16 v[32:47], v[16:19], v[248:251], v[32:47]
    ds_read_b64_tr_b16 v[22:23], v9 offset:19328
    ds_read_b64_tr_b16 v[28:29], v9 offset:18624
    s_waitcnt lgkmcnt(1)
    v_mfma_f32_32x32x16_bf16 v[48:63], v[20:23], v[248:251], v[48:63]
    ds_read_b64_tr_b16 v[26:27], v9 offset:19360
    ds_read_b64_tr_b16 v[16:17], v9 offset:18656
    s_waitcnt lgkmcnt(1)
    v_mfma_f32_32x32x16_bf16 v[64:79], v[24:27], v[248:251], v[64:79]
    ds_read_b64_tr_b16 v[30:31], v9 offset:19392
    ds_read_b64_tr_b16 v[20:21], v9 offset:18688
    s_waitcnt lgkmcnt(1)
    v_mfma_f32_32x32x16_bf16 v[80:95], v[28:31], v[248:251], v[80:95]
    ds_read_b64_tr_b16 v[18:19], v9 offset:19424
    ds_read_b64_tr_b16 v[24:25], v9 offset:51296
    s_waitcnt lgkmcnt(1)
    s_cbranch_vccnz L_sk_93
    v_mfma_f32_32x32x16_bf16 v[96:111], v[16:19], v[248:251], v[96:111]
L_sk_93:
    ds_read_b64_tr_b16 v[22:23], v9 offset:19456
    ds_read_b64_tr_b16 v[28:29], v9 offset:51328
    s_waitcnt lgkmcnt(1)
    s_cbranch_vccnz L_sk_94
    v_mfma_f32_32x32x16_bf16 v[112:127], v[20:23], v[248:251], v[112:127]
L_sk_94:
    ds_read_b64_tr_b16 v[26:27], v9 offset:52064
    ds_read_b64_tr_b16 v[16:17], v9 offset:51360
    s_waitcnt lgkmcnt(1)
    v_mfma_f32_32x32x16_bf16 v[32:47], v[24:27], v[252:255], v[32:47]
    ds_read_b64_tr_b16 v[30:31], v9 offset:52096
    ds_read_b64_tr_b16 v[20:21], v9 offset:51392
    s_waitcnt lgkmcnt(1)
    v_mfma_f32_32x32x16_bf16 v[48:63], v[28:31], v[252:255], v[48:63]
    ds_read_b64_tr_b16 v[18:19], v9 offset:52128
    ds_read_b64_tr_b16 v[24:25], v9 offset:51424
    s_waitcnt lgkmcnt(1)
    v_mfma_f32_32x32x16_bf16 v[64:79], v[16:19], v[252:255], v[64:79]
    ds_read_b64_tr_b16 v[22:23], v9 offset:52160
    ds_read_b64_tr_b16 v[28:29], v9 offset:51456
    s_waitcnt lgkmcnt(1)
    v_mfma_f32_32x32x16_bf16 v[80:95], v[20:23], v[252:255], v[80:95]
    ds_read_b64_tr_b16 v[26:27], v9 offset:52192
    s_waitcnt lgkmcnt(0)
    s_cbranch_vccnz L_sk_95
    v_mfma_f32_32x32x16_bf16 v[96:111], v[24:27], v[252:255], v[96:111]
L_sk_95:
    ds_read_b64_tr_b16 v[30:31], v9 offset:52224
    s_waitcnt lgkmcnt(0)
    s_cbranch_vccnz L_sk_96
    v_mfma_f32_32x32x16_bf16 v[112:127], v[28:31], v[252:255], v[112:127]
L_sk_96:
    ds_add_u32 v1, v2 offset:48
    s_mov_b32 s92, 0xbdd2d3e8
    s_mov_b32 s93, 0xbdd2d3e8
    s_setprio 2
    v_mul_f32 v14, 0x3fb8aa3b, v14
    v_min_f32 v14, 0x42e60000, v14
    v_exp_f32 v14, v14
    v_mov_b32 v12, 0xc0135761
    v_add_f32 v14, 1.0, v14
    s_mul_i32 s88, s7, 86
    s_add_u32 s88, s88, s82
    s_lshl_b32 s88, s88, 10
    s_add_u32 s88, s88, 3145728
    v_pk_mul_f32 v[128:129], v[32:33], v[32:33]
    v_pk_mul_f32 v[130:131], v[34:35], v[34:35]
    v_pk_mul_f32 v[132:133], v[36:37], v[36:37]
    v_pk_mul_f32 v[134:135], v[38:39], v[38:39]
    v_pk_fma_f32 v[128:129], v[128:129], s[92:93], v[12:13] op_sel_hi:[1,1,0]
    v_pk_fma_f32 v[130:131], v[130:131], s[92:93], v[12:13] op_sel_hi:[1,1,0]
    v_pk_fma_f32 v[132:133], v[132:133], s[92:93], v[12:13] op_sel_hi:[1,1,0]
    v_pk_fma_f32 v[134:135], v[134:135], s[92:93], v[12:13] op_sel_hi:[1,1,0]
    v_pk_mul_f32 v[128:129], v[128:129], v[32:33]
    v_pk_mul_f32 v[130:131], v[130:131], v[34:35]
    v_pk_mul_f32 v[132:133], v[132:133], v[36:37]
    v_pk_mul_f32 v[134:135], v[134:135], v[38:39]
    v_exp_f32 v128, v128
    v_exp_f32 v129, v129
    v_exp_f32 v130, v130
    v_exp_f32 v131, v131
    v_exp_f32 v132, v132
    v_exp_f32 v133, v133
    v_exp_f32 v134, v134
    v_exp_f32 v135, v135
    v_pk_mul_f32 v[32:33], v[32:33], v[40:41]
    v_pk_mul_f32 v[34:35], v[34:35], v[42:43]
    v_pk_mul_f32 v[36:37], v[36:37], v[44:45]
    v_pk_mul_f32 v[38:39], v[38:39], v[46:47]
    v_pk_fma_f32 v[128:129], v[128:129], v[14:15], v[14:15] op_sel_hi:[1,0,0]
    v_pk_fma_f32 v[130:131], v[130:131], v[14:15], v[14:15] op_sel_hi:[1,0,0]
    v_pk_fma_f32 v[132:133], v[132:133], v[14:15], v[14:15] op_sel_hi:[1,0,0]
    v_pk_fma_f32 v[134:135], v[134:135], v[14:15], v[14:15] op_sel_hi:[1,0,0]
    v_rcp_f32 v128, v128
    v_rcp_f32 v129, v129
    v_rcp_f32 v130, v130
    v_rcp_f32 v131, v131
    v_rcp_f32 v132, v132
    v_rcp_f32 v133, v133
    v_rcp_f32 v134, v134
    v_rcp_f32 v135, v135
    s_nop 0
    v_pk_mul_f32 v[32:33], v[32:33], v[128:129]
    v_pk_mul_f32 v[34:35], v[34:35], v[130:131]
    v_pk_mul_f32 v[36:37], v[36:37], v[132:133]
    v_pk_mul_f32 v[38:39], v[38:39], v[134:135]
    v_cvt_pk_bf16_f32 v136, v32, v33
    v_cvt_pk_bf16_f32 v137, v34, v35
    v_cvt_pk_bf16_f32 v138, v36, v37
    v_cvt_pk_bf16_f32 v139, v38, v39
    s_add_u32 s81, s88, 0
    buffer_store_dwordx4 v[136:139], v4, s[72:75], s81 offen sc1
    v_pk_mul_f32 v[144:145], v[48:49], v[48:49]
    v_pk_mul_f32 v[146:147], v[50:51], v[50:51]
    v_pk_mul_f32 v[148:149], v[52:53], v[52:53]
    v_pk_mul_f32 v[150:151], v[54:55], v[54:55]
    v_pk_fma_f32 v[144:145], v[144:145], s[92:93], v[12:13] op_sel_hi:[1,1,0]
    v_pk_fma_f32 v[146:147], v[146:147], s[92:93], v[12:13] op_sel_hi:[1,1,0]
    v_pk_fma_f32 v[148:149], v[148:149], s[92:93], v[12:13] op_sel_hi:[1,1,0]
    v_pk_fma_f32 v[150:151], v[150:151], s[92:93], v[12:13] op_sel_hi:[1,1,0]
    v_pk_mul_f32 v[144:145], v[144:145], v[48:49]
    v_pk_mul_f32 v[146:147], v[146:147], v[50:51]
    v_pk_mul_f32 v[148:149], v[148:149], v[52:53]
    v_pk_mul_f32 v[150:151], v[150:151], v[54:55]
    v_exp_f32 v144, v144
    v_exp_f32 v145, v145
    v_exp_f32 v146, v146
    v_exp_f32 v147, v147
    v_exp_f32 v148, v148
    v_exp_f32 v149, v149
    v_exp_f32 v150, v150
    v_exp_f32 v151, v151
    v_pk_mul_f32 v[48:49], v[48:49], v[56:57]
    v_pk_mul_f32 v[50:51], v[50:51], v[58:59]
    v_pk_mul_f32 v[52:53], v[52:53], v[60:61]
    v_pk_mul_f32 v[54:55], v[54:55], v[62:63]
    v_pk_fma_f32 v[144:145], v[144:145], v[14:15], v[14:15] op_sel_hi:[1,0,0]
    v_pk_fma_f32 v[146:147], v[146:147], v[14:15], v[14:15] op_sel_hi:[1,0,0]
    v_pk_fma_f32 v[148:149], v[148:149], v[14:15], v[14:15] op_sel_hi:[1,0,0]
    v_pk_fma_f32 v[150:151], v[150:151], v[14:15], v[14:15] op_sel_hi:[1,0,0]
    v_rcp_f32 v144, v144
    v_rcp_f32 v145, v145
    v_rcp_f32 v146, v146
    v_rcp_f32 v147, v147
    v_rcp_f32 v148, v148
    v_rcp_f32 v149, v149
    v_rcp_f32 v150, v150
    v_rcp_f32 v151, v151
    s_nop 0
    v_pk_mul_f32 v[48:49], v[48:49], v[144:145]
    v_pk_mul_f32 v[50:51], v[50:51], v[146:147]
    v_pk_mul_f32 v[52:53], v[52:53], v[148:149]
    v_pk_mul_f32 v[54:55], v[54:55], v[150:151]
    v_cvt_pk_bf16_f32 v152, v48, v49
    v_cvt_pk_bf16_f32 v153, v50, v51
    v_cvt_pk_bf16_f32 v154, v52, v53
    v_cvt_pk_bf16_f32 v155, v54, v55
    s_add_u32 s81, s88, 1024
    buffer_store_dwordx4 v[152:155], v4, s[72:75], s81 offen sc1
    v_pk_mul_f32 v[128:129], v[64:65], v[64:65]
    v_pk_mul_f32 v[130:131], v[66:67], v[66:67]
    v_pk_mul_f32 v[132:133], v[68:69], v[68:69]
    v_pk_mul_f32 v[134:135], v[70:71], v[70:71]
    v_pk_fma_f32 v[128:129], v[128:129], s[92:93], v[12:13] op_sel_hi:[1,1,0]
    v_pk_fma_f32 v[130:131], v[130:131], s[92:93], v[12:13] op_sel_hi:[1,1,0]
    v_pk_fma_f32 v[132:133], v[132:133], s[92:93], v[12:13] op_sel_hi:[1,1,0]
    v_pk_fma_f32 v[134:135], v[134:135], s[92:93], v[12:13] op_sel_hi:[1,1,0]
    v_pk_mul_f32 v[128:129], v[128:129], v[64:65]
    v_pk_mul_f32 v[130:131], v[130:131], v[66:67]
    v_pk_mul_f32 v[132:133], v[132:133], v[68:69]
    v_pk_mul_f32 v[134:135], v[134:135], v[70:71]
    v_exp_f32 v128, v128
    v_exp_f32 v129, v129
    v_exp_f32 v130, v130
    v_exp_f32 v131, v131
    v_exp_f32 v132, v132
    v_exp_f32 v133, v133
    v_exp_f32 v134, v134
    v_exp_f32 v135, v135
    v_pk_mul_f32 v[64:65], v[64:65], v[72:73]
    v_pk_mul_f32 v[66:67], v[66:67], v[74:75]
    v_pk_mul_f32 v[68:69], v[68:69], v[76:77]
    v_pk_mul_f32 v[70:71], v[70:71], v[78:79]
    v_pk_fma_f32 v[128:129], v[128:129], v[14:15], v[14:15] op_sel_hi:[1,0,0]
    v_pk_fma_f32 v[130:131], v[130:131], v[14:15], v[14:15] op_sel_hi:[1,0,0]
    v_pk_fma_f32 v[132:133], v[132:133], v[14:15], v[14:15] op_sel_hi:[1,0,0]
    v_pk_fma_f32 v[134:135], v[134:135], v[14:15], v[14:15] op_sel_hi:[1,0,0]
    v_rcp_f32 v128, v128
    v_rcp_f32 v129, v129
    v_rcp_f32 v130, v130
    v_rcp_f32 v131, v131
    v_rcp_f32 v132, v132
    v_rcp_f32 v133, v133
    v_rcp_f32 v134, v134
    v_rcp_f32 v135, v135
    s_nop 0
    v_pk_mul_f32 v[64:65], v[64:65], v[128:129]
    v_pk_mul_f32 v[66:67], v[66:67], v[130:131]
    v_pk_mul_f32 v[68:69], v[68:69], v[132:133]
    v_pk_mul_f32 v[70:71], v[70:71], v[134:135]
    v_cvt_pk_bf16_f32 v136, v64, v65
    v_cvt_pk_bf16_f32 v137, v66, v67
    v_cvt_pk_bf16_f32 v138, v68, v69
    v_cvt_pk_bf16_f32 v139, v70, v71
    s_add_u32 s81, s88, 2048
    buffer_store_dwordx4 v[136:139], v4, s[72:75], s81 offen sc1
    v_pk_mul_f32 v[144:145], v[80:81], v[80:81]
    v_pk_mul_f32 v[146:147], v[82:83], v[82:83]
    v_pk_mul_f32 v[148:149], v[84:85], v[84:85]
    v_pk_mul_f32 v[150:151], v[86:87], v[86:87]
    v_pk_fma_f32 v[144:145], v[144:145], s[92:93], v[12:13] op_sel_hi:[1,1,0]
    v_pk_fma_f32 v[146:147], v[146:147], s[92:93], v[12:13] op_sel_hi:[1,1,0]
    v_pk_fma_f32 v[148:149], v[148:149], s[92:93], v[12:13] op_sel_hi:[1,1,0]
    v_pk_fma_f32 v[150:151], v[150:151], s[92:93], v[12:13] op_sel_hi:[1,1,0]
    v_pk_mul_f32 v[144:145], v[144:145], v[80:81]
    v_pk_mul_f32 v[146:147], v[146:147], v[82:83]
    v_pk_mul_f32 v[148:149], v[148:149], v[84:85]
    v_pk_mul_f32 v[150:151], v[150:151], v[86:87]
    v_exp_f32 v144, v144
    v_exp_f32 v145, v145
    v_exp_f32 v146, v146
    v_exp_f32 v147, v147
    v_exp_f32 v148, v148
    v_exp_f32 v149, v149
    v_exp_f32 v150, v150
    v_exp_f32 v151, v151
    v_pk_mul_f32 v[80:81], v[80:81], v[88:89]
    v_pk_mul_f32 v[82:83], v[82:83], v[90:91]
    v_pk_mul_f32 v[84:85], v[84:85], v[92:93]
    v_pk_mul_f32 v[86:87], v[86:87], v[94:95]
    v_pk_fma_f32 v[144:145], v[144:145], v[14:15], v[14:15] op_sel_hi:[1,0,0]
    v_pk_fma_f32 v[146:147], v[146:147], v[14:15], v[14:15] op_sel_hi:[1,0,0]
    v_pk_fma_f32 v[148:149], v[148:149], v[14:15], v[14:15] op_sel_hi:[1,0,0]
    v_pk_fma_f32 v[150:151], v[150:151], v[14:15], v[14:15] op_sel_hi:[1,0,0]
    v_rcp_f32 v144, v144
    v_rcp_f32 v145, v145
    v_rcp_f32 v146, v146
    v_rcp_f32 v147, v147
    v_rcp_f32 v148, v148
    v_rcp_f32 v149, v149
    v_rcp_f32 v150, v150
    v_rcp_f32 v151, v151
    s_nop 0
    v_pk_mul_f32 v[80:81], v[80:81], v[144:145]
    v_pk_mul_f32 v[82:83], v[82:83], v[146:147]
    v_pk_mul_f32 v[84:85], v[84:85], v[148:149]
    v_pk_mul_f32 v[86:87], v[86:87], v[150:151]
    v_cvt_pk_bf16_f32 v152, v80, v81
    v_cvt_pk_bf16_f32 v153, v82, v83
    v_cvt_pk_bf16_f32 v154, v84, v85
    v_cvt_pk_bf16_f32 v155, v86, v87
    s_add_u32 s81, s88, 3072
    buffer_store_dwordx4 v[152:155], v4, s[72:75], s81 offen sc1
    s_cbranch_vccnz L_G_gelu_done
    v_pk_mul_f32 v[128:129], v[96:97], v[96:97]
    v_pk_mul_f32 v[130:131], v[98:99], v[98:99]
    v_pk_mul_f32 v[132:133], v[100:101], v[100:101]
    v_pk_mul_f32 v[134:135], v[102:103], v[102:103]
    v_pk_fma_f32 v[128:129], v[128:129], s[92:93], v[12:13] op_sel_hi:[1,1,0]
    v_pk_fma_f32 v[130:131], v[130:131], s[92:93], v[12:13] op_sel_hi:[1,1,0]
    v_pk_fma_f32 v[132:133], v[132:133], s[92:93], v[12:13] op_sel_hi:[1,1,0]
    v_pk_fma_f32 v[134:135], v[134:135], s[92:93], v[12:13] op_sel_hi:[1,1,0]
    v_pk_mul_f32 v[128:129], v[128:129], v[96:97]
    v_pk_mul_f32 v[130:131], v[130:131], v[98:99]
    v_pk_mul_f32 v[132:133], v[132:133], v[100:101]
    v_pk_mul_f32 v[134:135], v[134:135], v[102:103]
    v_exp_f32 v128, v128
    v_exp_f32 v129, v129
    v_exp_f32 v130, v130
    v_exp_f32 v131, v131
    v_exp_f32 v132, v132
    v_exp_f32 v133, v133
    v_exp_f32 v134, v134
    v_exp_f32 v135, v135
    v_pk_mul_f32 v[96:97], v[96:97], v[104:105]
    v_pk_mul_f32 v[98:99], v[98:99], v[106:107]
    v_pk_mul_f32 v[100:101], v[100:101], v[108:109]
    v_pk_mul_f32 v[102:103], v[102:103], v[110:111]
    v_pk_fma_f32 v[128:129], v[128:129], v[14:15], v[14:15] op_sel_hi:[1,0,0]
    v_pk_fma_f32 v[130:131], v[130:131], v[14:15], v[14:15] op_sel_hi:[1,0,0]
    v_pk_fma_f32 v[132:133], v[132:133], v[14:15], v[14:15] op_sel_hi:[1,0,0]
    v_pk_fma_f32 v[134:135], v[134:135], v[14:15], v[14:15] op_sel_hi:[1,0,0]
    v_rcp_f32 v128, v128
    v_rcp_f32 v129, v129
    v_rcp_f32 v130, v130
    v_rcp_f32 v131, v131
    v_rcp_f32 v132, v132
    v_rcp_f32 v133, v133
    v_rcp_f32 v134, v134
    v_rcp_f32 v135, v135
    s_nop 0
    v_pk_mul_f32 v[96:97], v[96:97], v[128:129]
    v_pk_mul_f32 v[98:99], v[98:99], v[130:131]
    v_pk_mul_f32 v[100:101], v[100:101], v[132:133]
    v_pk_mul_f32 v[102:103], v[102:103], v[134:135]
    v_cvt_pk_bf16_f32 v136, v96, v97
    v_cvt_pk_bf16_f32 v137, v98, v99
    v_cvt_pk_bf16_f32 v138, v100, v101
    v_cvt_pk_bf16_f32 v139, v102, v103
    s_add_u32 s81, s88, 4096
    buffer_store_dwordx4 v[136:139], v4, s[72:75], s81 offen sc1
    v_pk_mul_f32 v[144:145], v[112:113], v[112:113]
    v_pk_mul_f32 v[146:147], v[114:115], v[114:115]
    v_pk_mul_f32 v[148:149], v[116:117], v[116:117]
    v_pk_mul_f32 v[150:151], v[118:119], v[118:119]
    v_pk_fma_f32 v[144:145], v[144:145], s[92:93], v[12:13] op_sel_hi:[1,1,0]
    v_pk_fma_f32 v[146:147], v[146:147], s[92:93], v[12:13] op_sel_hi:[1,1,0]
    v_pk_fma_f32 v[148:149], v[148:149], s[92:93], v[12:13] op_sel_hi:[1,1,0]
    v_pk_fma_f32 v[150:151], v[150:151], s[92:93], v[12:13] op_sel_hi:[1,1,0]
    v_pk_mul_f32 v[144:145], v[144:145], v[112:113]
    v_pk_mul_f32 v[146:147], v[146:147], v[114:115]
    v_pk_mul_f32 v[148:149], v[148:149], v[116:117]
    v_pk_mul_f32 v[150:151], v[150:151], v[118:119]
    v_exp_f32 v144, v144
    v_exp_f32 v145, v145
    v_exp_f32 v146, v146
    v_exp_f32 v147, v147
    v_exp_f32 v148, v148
    v_exp_f32 v149, v149
    v_exp_f32 v150, v150
    v_exp_f32 v151, v151
    v_pk_mul_f32 v[112:113], v[112:113], v[120:121]
    v_pk_mul_f32 v[114:115], v[114:115], v[122:123]
    v_pk_mul_f32 v[116:117], v[116:117], v[124:125]
    v_pk_mul_f32 v[118:119], v[118:119], v[126:127]
    v_pk_fma_f32 v[144:145], v[144:145], v[14:15], v[14:15] op_sel_hi:[1,0,0]
    v_pk_fma_f32 v[146:147], v[146:147], v[14:15], v[14:15] op_sel_hi:[1,0,0]
    v_pk_fma_f32 v[148:149], v[148:149], v[14:15], v[14:15] op_sel_hi:[1,0,0]
    v_pk_fma_f32 v[150:151], v[150:151], v[14:15], v[14:15] op_sel_hi:[1,0,0]
    v_rcp_f32 v144, v144
    v_rcp_f32 v145, v145
    v_rcp_f32 v146, v146
    v_rcp_f32 v147, v147
    v_rcp_f32 v148, v148
    v_rcp_f32 v149, v149
    v_rcp_f32 v150, v150
    v_rcp_f32 v151, v151
    s_nop 0
    v_pk_mul_f32 v[112:113], v[112:113], v[144:145]
    v_pk_mul_f32 v[114:115], v[114:115], v[146:147]
    v_pk_mul_f32 v[116:117], v[116:117], v[148:149]
    v_pk_mul_f32 v[118:119], v[118:119], v[150:151]
    v_cvt_pk_bf16_f32 v152, v112, v113
    v_cvt_pk_bf16_f32 v153, v114, v115
    v_cvt_pk_bf16_f32 v154, v116, v117
    v_cvt_pk_bf16_f32 v155, v118, v119
    s_add_u32 s81, s88, 5120
    buffer_store_dwordx4 v[152:155], v4, s[72:75], s81 offen sc1
L_G_gelu_done:
    v_bfe_u32 v16, v0, 2, 2
    v_and_b32 v17, 3, v0
    v_lshlrev_b32 v17, 3, v17
    v_bfe_u32 v18, v0, 4, 1
    v_lshrrev_b32 v19, 5, v0
    v_lshl_add_u32 v19, v19, 2, v16
    v_lshl_add_u32 v17, v19, 7, v17
    v_lshl_add_u32 v17, v18, 5, v17
    v_lshrrev_b32 v16, 1, v16
    v_lshl_add_u32 v17, v16, 6, v17
    v_add_u32 v10, s78, v17
    s_and_b32 s79, s6, 1
    s_lshl_b32 s79, s79, 6
    v_xor_b32 v10, s79, v10
    v_xor_b32 v11, 64, v10
    v_add_u32 v14, 7168, v13
    v_lshrrev_b32 v20, 1, v0
    v_min_u32 v20, 4, v20
    s_lshl_b32 s79, s6, 2
    v_add_u32 v20, s79, v20
    v_min_u32 v20, 15, v20
    v_lshlrev_b32 v20, 2, v20
    v_and_b32 v3, 1, v0
    v_add_u32 v20, v20, v3
    v_lshlrev_b32 v20, 7, v20
    s_setprio 0
    ds_read_b32 v3, v1 offset:48
    s_waitcnt lgkmcnt(0)
    s_setprio 2
    v_readfirstlane_b32 s84, v3
    s_setprio 0
    s_cmp_ge_u32 s84, 4
    s_cbranch_scc0 L_spin_98
L_ok_97:
    s_lshl_b32 s80, s94, 14
    s_add_u32 s94, s94, 1
    s_cmp_eq_u32 s94, s91
    s_cselect_b32 s94, s90, s94
    s_add_u32 m0, s78, 12288
    s_nop 0
    buffer_load_dwordx4 v13, s[60:63], s80 offen lds
    buffer_load_dwordx4 v14, s[60:63], s80 offen offset:1024 lds
    s_lshl_b32 s80, s94, 14
    s_add_u32 s94, s94, 1
    s_cmp_eq_u32 s94, s91
    s_cselect_b32 s94, s90, s94
    s_add_u32 m0, s78, 14336
    s_nop 0
    buffer_load_dwordx4 v13, s[60:63], s80 offen lds
    buffer_load_dwordx4 v14, s[60:63], s80 offen offset:1024 lds
    s_lshl_b32 s79, s4, 4
    s_add_u32 s79, s79, s5
    s_lshl_b32 s79, s79, 2
    s_add_u32 s79, s79, s6
    s_lshl_b32 s79, s79, 7
    s_add_u32 s79, s79, 65536
    s_waitcnt vmcnt(4)
    s_mov_b64 exec, 1
    buffer_store_dwordx2 v[6:7], off, s[72:75], s79 sc1
    s_mov_b64 exec, -1
    s_lshl_b32 s80, s94, 14
    s_add_u32 s94, s94, 1
    s_cmp_eq_u32 s94, s91
    s_cselect_b32 s94, s90, s94
    s_add_u32 m0, s78, 16384
    s_nop 0
    buffer_load_dwordx4 v13, s[60:63], s80 offen lds
    buffer_load_dwordx4 v14, s[60:63], s80 offen offset:1024 lds
    s_lshl_b32 s80, s94, 14
    s_add_u32 s94, s94, 1
    s_cmp_eq_u32 s94, s91
    s_cselect_b32 s94, s90, s94
    s_add_u32 m0, s78, 18432
    s_nop 0
    buffer_load_dwordx4 v13, s[60:63], s80 offen lds
    buffer_load_dwordx4 v14, s[60:63], s80 offen offset:1024 lds
    s_lshl_b32 s80, s94, 14
    s_add_u32 s94, s94, 1
    s_cmp_eq_u32 s94, s91
    s_cselect_b32 s94, s90, s94
    s_add_u32 m0, s78, 20480
    s_nop 0
    buffer_load_dwordx4 v13, s[60:63], s80 offen lds
    buffer_load_dwordx4 v14, s[60:63], s80 offen offset:1024 lds
    s_lshl_b32 s80, s94, 14
    s_add_u32 s94, s94, 1
    s_cmp_eq_u32 s94, s91
    s_cselect_b32 s94, s90, s94
    s_add_u32 m0, s78, 22528
    s_nop 0
    buffer_load_dwordx4 v13, s[60:63], s80 offen lds
    buffer_load_dwordx4 v14, s[60:63], s80 offen offset:1024 lds
    ds_read_b64_tr_b16 v[192:193], v10 offset:26784
    ds_read_b64_tr_b16 v[194:195], v10 offset:27808
    ds_read_b64_tr_b16 v[196:197], v11 offset:26784
    ds_read_b64_tr_b16 v[198:199], v11 offset:27808
    ds_read_b64_tr_b16 v[200:201], v10 offset:28832
    ds_read_b64_tr_b16 v[202:203], v10 offset:29856
    ds_read_b64_tr_b16 v[204:205], v11 offset:28832
    ds_read_b64_tr_b16 v[206:207], v11 offset:29856
    ds_read_b64_tr_b16 v[208:209], v10 offset:0
    ds_read_b64_tr_b16 v[210:211], v10 offset:1024
    ds_read_b64_tr_b16 v[212:213], v11 offset:0
    ds_read_b64_tr_b16 v[214:215], v11 offset:1024
    s_waitcnt lgkmcnt(8)
    s_lshl_b32 s80, s94, 14
    s_add_u32 s94, s94, 1
    s_cmp_eq_u32 s94, s91
    s_cselect_b32 s94, s90, s94
    s_add_u32 m0, s78, 26784
    s_nop 0
    buffer_load_dwordx4 v13, s[60:63], s80 offen lds
    buffer_load_dwordx4 v14, s[60:63], s80 offen offset:1024 lds
    ds_read_b64_tr_b16 v[216:217], v10 offset:2048
    ds_read_b64_tr_b16 v[218:219], v10 offset:3072
    ds_read_b64_tr_b16 v[220:221], v11 offset:2048
    ds_read_b64_tr_b16 v[222:223], v11 offset:3072
    s_waitcnt lgkmcnt(8)
    s_lshl_b32 s80, s94, 14
    s_add_u32 s94, s94, 1
    s_cmp_eq_u32 s94, s91
    s_cselect_b32 s94, s90, s94
    s_add_u32 m0, s78, 28832
    s_nop 0
    buffer_load_dwordx4 v13, s[60:63], s80 offen lds
    buffer_load_dwordx4 v14, s[60:63], s80 offen offset:1024 lds
    ds_read_b64_tr_b16 v[224:225], v10 offset:4096
    ds_read_b64_tr_b16 v[226:227], v10 offset:5120
    ds_read_b64_tr_b16 v[228:229], v11 offset:4096
    ds_read_b64_tr_b16 v[230:231], v11 offset:5120
    s_waitcnt lgkmcnt(8)
    s_lshl_b32 s80, s94, 14
    s_add_u32 s94, s94, 1
    s_cmp_eq_u32 s94, s91
    s_cselect_b32 s94, s90, s94
    s_add_u32 m0, s78, 0
    s_nop 0
    buffer_load_dwordx4 v13, s[60:63], s80 offen lds
    buffer_load_dwordx4 v14, s[60:63], s80 offen offset:1024 lds
    ds_read_b64_tr_b16 v[232:233], v10 offset:6144
    ds_read_b64_tr_b16 v[234:235], v10 offset:7168
    ds_read_b64_tr_b16 v[236:237], v11 offset:6144
    ds_read_b64_tr_b16 v[238:239], v11 offset:7168
    s_waitcnt lgkmcnt(8)
    s_lshl_b32 s80, s94, 14
    s_add_u32 s94, s94, 1
    s_cmp_eq_u32 s94, s91
    s_cselect_b32 s94, s90, s94
    s_add_u32 m0, s78, 2048
    s_nop 0
    buffer_load_dwordx4 v13, s[60:63], s80 offen lds
    buffer_load_dwordx4 v14, s[60:63], s80 offen offset:1024 lds
    s_waitcnt lgkmcnt(4)
    s_lshl_b32 s80, s94, 14
    s_add_u32 s94, s94, 1
    s_cmp_eq_u32 s94, s91
    s_cselect_b32 s94, s90, s94
    s_add_u32 m0, s78, 4096
    s_nop 0
    buffer_load_dwordx4 v13, s[60:63], s80 offen lds
    buffer_load_dwordx4 v14, s[60:63], s80 offen offset:1024 lds
    s_waitcnt lgkmcnt(0)
    s_lshl_b32 s80, s94, 14
    s_add_u32 s94, s94, 1
    s_cmp_eq_u32 s94, s91
    s_cselect_b32 s94, s90, s94
    s_add_u32 m0, s78, 6144
    s_nop 0
    buffer_load_dwordx4 v13, s[60:63], s80 offen lds
    buffer_load_dwordx4 v14, s[60:63], s80 offen offset:1024 lds
    s_lshr_b32 s79, s6, 1
    s_add_u32 s16, s89, s79
    s_xor_b32 s17, s16, 1
    s_sub_u32 s18, s17, s16
    s_lshl_b32 s28, s16, 15
    s_add_u32 s28, s28, 1048576
    s_lshl_b32 s29, s18, 15
    s_add_u32 s8, s101, 0
    s_and_b32 s8, s8, 3
    s_lshl_b32 s79, s6, 2
    s_add_u32 s8, s8, s79
    s_lshl_b32 s8, s8, 1
    s_lshl_b32 s8, s8, 10
    s_add_u32 s8, s8, s28
    s_add_u32 s9, s101, 1
    s_and_b32 s9, s9, 3
    s_lshl_b32 s79, s6, 2
    s_add_u32 s9, s9, s79
    s_lshl_b32 s9, s9, 1
    s_lshl_b32 s9, s9, 10
    s_add_u32 s9, s9, s28
    s_add_u32 s10, s101, 2
    s_and_b32 s10, s10, 3
    s_lshl_b32 s79, s6, 2
    s_add_u32 s10, s10, s79
    s_lshl_b32 s10, s10, 1
    s_lshl_b32 s10, s10, 10
    s_add_u32 s10, s10, s28
    s_add_u32 s11, s101, 3
    s_and_b32 s11, s11, 3
    s_lshl_b32 s79, s6, 2
    s_add_u32 s11, s11, s79
    s_lshl_b32 s11, s11, 1
    s_lshl_b32 s11, s11, 10
    s_add_u32 s11, s11, s28
    s_add_u32 s12, s101, 4
    s_and_b32 s12, s12, 3
    s_lshl_b32 s79, s6, 2
    s_add_u32 s12, s12, s79
    s_lshl_b32 s12, s12, 1
    s_add_u32 s12, s12, 1
    s_lshl_b32 s12, s12, 10
    s_add_u32 s12, s12, s28
    s_add_u32 s13, s101, 5
    s_and_b32 s13, s13, 3
    s_lshl_b32 s79, s6, 2
    s_add_u32 s13, s13, s79
    s_lshl_b32 s13, s13, 1
    s_add_u32 s13, s13, 1
    s_lshl_b32 s13, s13, 10
    s_add_u32 s13, s13, s28
    s_add_u32 s14, s101, 6
    s_and_b32 s14, s14, 3
    s_lshl_b32 s79, s6, 2
    s_add_u32 s14, s14, s79
    s_lshl_b32 s14, s14, 1
    s_add_u32 s14, s14, 1
    s_lshl_b32 s14, s14, 10
    s_add_u32 s14, s14, s28
    s_add_u32 s15, s101, 7
    s_and_b32 s15, s15, 3
    s_lshl_b32 s79, s6, 2
    s_add_u32 s15, s15, s79
    s_lshl_b32 s15, s15, 1
    s_add_u32 s15, s15, 1
    s_lshl_b32 s15, s15, 10
    s_add_u32 s15, s15, s28
    s_lshl_b32 s79, s16, 15
    s_and_b32 s80, s5, 7
    s_lshl_b32 s80, s80, 7
    s_add_u32 s79, s79, s80
    s_and_b32 s80, s6, 1
    s_lshl_b32 s80, s80, 6
    s_add_u32 s86, s79, s80
    s_setprio 2
    v_add_u32 v8, s78, v4
    s_xor_b32 s79, s78, 32768
    v_add_u32 v5, s79, v4
    s_xor_b32 s79, s78, 65536
    v_add_u32 v6, s79, v4
    s_xor_b32 s79, s78, 98304
    v_add_u32 v7, s79, v4
    v_and_b32 v9, 31, v0
    v_lshlrev_b32 v9, 10, v9
    v_lshrrev_b32 v3, 5, v0
    v_lshl_add_u32 v9, v3, 4, v9
    s_setprio 0
    s_lshl_b32 s80, s4, 6
    s_and_b32 s79, s89, 3
    s_add_u32 s80, s80, s79
    s_lshl_b32 s80, s80, 7
    s_add_u32 s80, s80, 65536
    s_getpc_b64 s[24:25]
L_pc2:
    s_add_u32 s24, s24, L_G_tail-L_pc2
    s_addc_u32 s25, s25, 0
    s_setprio 2
    v_and_b32 v24, 15, v0
    v_lshlrev_b32 v24, 7, v24
    s_lshl_b32 s79, s6, 11
    v_add_u32 v24, s79, v24
    s_mov_b32 exec_lo, 0
    v_add_u32 v24, L_A_last-L_G_tail, v24
    s_mov_b32 exec_lo, -1
    v_min_u32 v24, L_exit-L_G_tail, v24
    s_setprio 0
    global_load_dword v25, v24, s[24:25]
L_gp_99:
    buffer_load_dwordx2 v[22:23], v20, s[72:75], s80 offen sc1
    s_waitcnt vmcnt(0)
    s_setprio 2
    v_cmp_ne_u64 vcc, s[76:77], v[22:23]
    s_setprio 0
    s_cbranch_vccz L_gpd_100
    s_sleep 6
    s_sub_u32 s83, s83, 1
    s_cbranch_scc0 L_gp_99
    s_mov_b32 s83, 0
L_gpd_100:
    s_mul_i32 s88, s16, 88064
    s_add_u32 s88, s88, 3145728
    s_mul_i32 s19, s18, 88064
    s_lshl_b32 s80, s95, 10
    s_add_u32 s80, s80, s88
    s_add_u32 s95, s95, 1
    s_cmp_eq_u32 s95, s91
    s_cselect_b32 s95, s90, s95
    buffer_load_dwordx4 v[96:99], v4, s[72:75], s80 offen sc1
    s_add_u32 s80, s80, s19
    buffer_load_dwordx4 v[100:103], v4, s[72:75], s80 offen sc1
    s_lshl_b32 s80, s95, 10
    s_add_u32 s80, s80, s88
    s_add_u32 s95, s95, 1
    s_cmp_eq_u32 s95, s91
    s_cselect_b32 s95, s90, s95
    buffer_load_dwordx4 v[104:107], v4, s[72:75], s80 offen sc1
    s_add_u32 s80, s80, s19
    buffer_load_dwordx4 v[108:111], v4, s[72:75], s80 offen sc1
    s_lshl_b32 s80, s95, 10
    s_add_u32 s80, s80, s88
    s_add_u32 s95, s95, 1
    s_cmp_eq_u32 s95, s91
    s_cselect_b32 s95, s90, s95
    buffer_load_dwordx4 v[112:115], v4, s[72:75], s80 offen sc1
    s_add_u32 s80, s80, s19
    buffer_load_dwordx4 v[116:119], v4, s[72:75], s80 offen sc1
    s_waitcnt vmcnt(4)
    v_mfma_f32_32x32x16_bf16 v[32:47], v[192:195], v[96:99], 0
    s_lshl_b32 s80, s95, 10
    s_add_u32 s80, s80, s88
    s_add_u32 s95, s95, 1
    s_cmp_eq_u32 s95, s91
    s_cselect_b32 s95, s90, s95
    buffer_load_dwordx4 v[120:123], v4, s[72:75], s80 offen sc1
    s_add_u32 s80, s80, s19
    buffer_load_dwordx4 v[124:127], v4, s[72:75], s80 offen sc1
    s_lshl_b32 s80, s95, 10
    s_add_u32 s80, s80, s88
    s_add_u32 s95, s95, 1
    s_cmp_eq_u32 s95, s91
    s_cselect_b32 s95, s90, s95
    buffer_load_dwordx4 v[128:131], v4, s[72:75], s80 offen sc1
    s_add_u32 s80, s80, s19
    buffer_load_dwordx4 v[132:135], v4, s[72:75], s80 offen sc1
    v_mfma_f32_32x32x16_bf16 v[64:79], v[192:195], v[100:103], 0
    v_mfma_f32_32x32x16_bf16 v[48:63], v[196:199], v[96:99], 0
    v_mfma_f32_32x32x16_bf16 v[80:95], v[196:199], v[100:103], 0
    s_waitcnt vmcnt(6)
    v_mfma_f32_32x32x16_bf16 v[32:47], v[200:203], v[104:107], v[32:47]
    s_lshl_b32 s80, s95, 10
    s_add_u32 s80, s80, s88
    s_add_u32 s95, s95, 1
    s_cmp_eq_u32 s95, s91
    s_cselect_b32 s95, s90, s95
    buffer_load_dwordx4 v[136:139], v4, s[72:75], s80 offen sc1
    s_add_u32 s80, s80, s19
    buffer_load_dwordx4 v[140:143], v4, s[72:75], s80 offen sc1
    s_lshl_b32 s80, s95, 10
    s_add_u32 s80, s80, s88
    s_add_u32 s95, s95, 1
    s_cmp_eq_u32 s95, s91
    s_cselect_b32 s95, s90, s95
    buffer_load_dwordx4 v[144:147], v4, s[72:75], s80 offen sc1
    s_add_u32 s80, s80, s19
    buffer_load_dwordx4 v[148:151], v4, s[72:75], s80 offen sc1
    v_mfma_f32_32x32x16_bf16 v[64:79], v[200:203], v[108:111], v[64:79]
    v_mfma_f32_32x32x16_bf16 v[48:63], v[204:207], v[104:107], v[48:63]
    v_mfma_f32_32x32x16_bf16 v[80:95], v[204:207], v[108:111], v[80:95]
    s_waitcnt vmcnt(8)
    v_mfma_f32_32x32x16_bf16 v[32:47], v[208:211], v[112:115], v[32:47]
    s_lshl_b32 s80, s95, 10
    s_add_u32 s80, s80, s88
    s_add_u32 s95, s95, 1
    s_cmp_eq_u32 s95, s91
    s_cselect_b32 s95, s90, s95
    buffer_load_dwordx4 v[152:155], v4, s[72:75], s80 offen sc1
    s_add_u32 s80, s80, s19
    buffer_load_dwordx4 v[156:159], v4, s[72:75], s80 offen sc1
    s_lshl_b32 s80, s95, 10
    s_add_u32 s80, s80, s88
    s_add_u32 s95, s95, 1
    s_cmp_eq_u32 s95, s91
    s_cselect_b32 s95, s90, s95
    buffer_load_dwordx4 v[160:163], v4, s[72:75], s80 offen sc1
    s_add_u32 s80, s80, s19
    buffer_load_dwordx4 v[164:167], v4, s[72:75], s80 offen sc1
    v_mfma_f32_32x32x16_bf16 v[64:79], v[208:211], v[116:119], v[64:79]
    v_mfma_f32_32x32x16_bf16 v[48:63], v[212:215], v[112:115], v[48:63]
    v_mfma_f32_32x32x16_bf16 v[80:95], v[212:215], v[116:119], v[80:95]
    s_waitcnt vmcnt(10)
    v_mfma_f32_32x32x16_bf16 v[32:47], v[216:219], v[120:123], v[32:47]
    s_lshl_b32 s80, s95, 10
    s_add_u32 s80, s80, s88
    s_add_u32 s95, s95, 1
    s_cmp_eq_u32 s95, s91
    s_cselect_b32 s95, s90, s95
    buffer_load_dwordx4 v[168:171], v4, s[72:75], s80 offen sc1
    s_add_u32 s80, s80, s19
    buffer_load_dwordx4 v[172:175], v4, s[72:75], s80 offen sc1
    s_lshl_b32 s80, s95, 10
    s_add_u32 s80, s80, s88
    s_add_u32 s95, s95, 1
    s_cmp_eq_u32 s95, s91
    s_cselect_b32 s95, s90, s95
    buffer_load_dwordx4 v[176:179], v4, s[72:75], s80 offen sc1
    s_add_u32 s80, s80, s19
    buffer_load_dwordx4 v[180:183], v4, s[72:75], s80 offen sc1
    v_mfma_f32_32x32x16_bf16 v[64:79], v[216:219], v[124:127], v[64:79]
    v_mfma_f32_32x32x16_bf16 v[48:63], v[220:223], v[120:123], v[48:63]
    v_mfma_f32_32x32x16_bf16 v[80:95], v[220:223], v[124:127], v[80:95]
    s_waitcnt vmcnt(12)
    v_mfma_f32_32x32x16_bf16 v[32:47], v[224:227], v[128:131], v[32:47]
    s_lshl_b32 s80, s95, 10
    s_add_u32 s80, s80, s88
    s_add_u32 s95, s95, 1
    s_cmp_eq_u32 s95, s91
    s_cselect_b32 s95, s90, s95
    buffer_load_dwordx4 v[184:187], v4, s[72:75], s80 offen sc1
    s_add_u32 s80, s80, s19
    buffer_load_dwordx4 v[188:191], v4, s[72:75], s80 offen sc1
    s_lshl_b32 s80, s95, 10
    s_add_u32 s80, s80, s88
    s_add_u32 s95, s95, 1
    s_cmp_eq_u32 s95, s91
    s_cselect_b32 s95, s90, s95
    buffer_load_dwordx4 v[96:99], v4, s[72:75], s80 offen sc1
    s_add_u32 s80, s80, s19
    buffer_load_dwordx4 v[100:103], v4, s[72:75], s80 offen sc1
    v_mfma_f32_32x32x16_bf16 v[64:79], v[224:227], v[132:135], v[64:79]
    v_mfma_f32_32x32x16_bf16 v[48:63], v[228:231], v[128:131], v[48:63]
    v_mfma_f32_32x32x16_bf16 v[80:95], v[228:231], v[132:135], v[80:95]
    s_waitcnt vmcnt(14)
    v_mfma_f32_32x32x16_bf16 v[32:47], v[232:235], v[136:139], v[32:47]
    s_lshl_b32 s80, s95, 10
    s_add_u32 s80, s80, s88
    s_add_u32 s95, s95, 1
    s_cmp_eq_u32 s95, s91
    s_cselect_b32 s95, s90, s95
    buffer_load_dwordx4 v[104:107], v4, s[72:75], s80 offen sc1
    s_add_u32 s80, s80, s19
    buffer_load_dwordx4 v[108:111], v4, s[72:75], s80 offen sc1
    s_lshl_b32 s80, s95, 10
    s_add_u32 s80, s80, s88
    s_add_u32 s95, s95, 1
    s_cmp_eq_u32 s95, s91
    s_cselect_b32 s95, s90, s95
    buffer_load_dwordx4 v[112:115], v4, s[72:75], s80 offen sc1
    s_add_u32 s80, s80, s19
    buffer_load_dwordx4 v[116:119], v4, s[72:75], s80 offen sc1
    v_mfma_f32_32x32x16_bf16 v[64:79], v[232:235], v[140:143], v[64:79]
    ds_read_b64_tr_b16 v[16:17], v10 offset:8192
    v_mfma_f32_32x32x16_bf16 v[48:63], v[236:239], v[136:139], v[48:63]
    v_mfma_f32_32x32x16_bf16 v[80:95], v[236:239], v[140:143], v[80:95]
    ds_read_b64_tr_b16 v[18:19], v10 offset:9216
    ds_read_b64_tr_b16 v[20:21], v11 offset:8192
    s_waitcnt vmcnt(16)
    s_waitcnt lgkmcnt(1)
    v_mfma_f32_32x32x16_bf16 v[32:47], v[16:19], v[144:147], v[32:47]
    s_lshl_b32 s80, s95, 10
    s_add_u32 s80, s80, s88
    s_add_u32 s95, s95, 1
    s_cmp_eq_u32 s95, s91
    s_cselect_b32 s95, s90, s95
    buffer_load_dwordx4 v[120:123], v4, s[72:75], s80 offen sc1
    s_add_u32 s80, s80, s19
    buffer_load_dwordx4 v[124:127], v4, s[72:75], s80 offen sc1
    s_lshl_b32 s80, s95, 10
    s_add_u32 s80, s80, s88
    s_add_u32 s95, s95, 1
    s_cmp_eq_u32 s95, s91
    s_cselect_b32 s95, s90, s95
    buffer_load_dwordx4 v[128:131], v4, s[72:75], s80 offen sc1
    s_add_u32 s80, s80, s19
    buffer_load_dwordx4 v[132:135], v4, s[72:75], s80 offen sc1
    v_mfma_f32_32x32x16_bf16 v[64:79], v[16:19], v[148:151], v[64:79]
    ds_read_b64_tr_b16 v[22:23], v11 offset:9216
    ds_read_b64_tr_b16 v[24:25], v10 offset:10240
    s_waitcnt lgkmcnt(1)
    v_mfma_f32_32x32x16_bf16 v[48:63], v[20:23], v[144:147], v[48:63]
    s_lshl_b32 s80, s94, 14
    s_add_u32 s94, s94, 1
    s_cmp_eq_u32 s94, s91
    s_cselect_b32 s94, s90, s94
    s_add_u32 m0, s78, 8192
    s_nop 0
    buffer_load_dwordx4 v13, s[60:63], s80 offen lds
    buffer_load_dwordx4 v14, s[60:63], s80 offen offset:1024 lds
    v_mfma_f32_32x32x16_bf16 v[80:95], v[20:23], v[148:151], v[80:95]
    ds_read_b64_tr_b16 v[26:27], v10 offset:11264
    ds_read_b64_tr_b16 v[28:29], v11 offset:10240
    s_waitcnt vmcnt(20)
    s_waitcnt lgkmcnt(1)
    v_mfma_f32_32x32x16_bf16 v[32:47], v[24:27], v[152:155], v[32:47]
    s_lshl_b32 s80, s95, 10
    s_add_u32 s80, s80, s88
    s_add_u32 s95, s95, 1
    s_cmp_eq_u32 s95, s91
    s_cselect_b32 s95, s90, s95
    buffer_load_dwordx4 v[136:139], v4, s[72:75], s80 offen sc1
    s_add_u32 s80, s80, s19
    buffer_load_dwordx4 v[140:143], v4, s[72:75], s80 offen sc1
    s_lshl_b32 s80, s95, 10
    s_add_u32 s80, s80, s88
    s_add_u32 s95, s95, 1
    s_cmp_eq_u32 s95, s91
    s_cselect_b32 s95, s90, s95
    buffer_load_dwordx4 v[144:147], v4, s[72:75], s80 offen sc1
    s_add_u32 s80, s80, s19
    buffer_load_dwordx4 v[148:151], v4, s[72:75], s80 offen sc1
    v_mfma_f32_32x32x16_bf16 v[64:79], v[24:27], v[156:159], v[64:79]
    ds_read_b64_tr_b16 v[30:31], v11 offset:11264
    ds_read_b64_tr_b16 v[16:17], v10 offset:12288
    s_waitcnt lgkmcnt(1)
    v_mfma_f32_32x32x16_bf16 v[48:63], v[28:31], v[152:155], v[48:63]
    s_lshl_b32 s80, s94, 14
    s_add_u32 s94, s94, 1
    s_cmp_eq_u32 s94, s91
    s_cselect_b32 s94, s90, s94
    s_add_u32 m0, s78, 10240
    s_nop 0
    buffer_load_dwordx4 v13, s[60:63], s80 offen lds
    buffer_load_dwordx4 v14, s[60:63], s80 offen offset:1024 lds
    v_mfma_f32_32x32x16_bf16 v[80:95], v[28:31], v[156:159], v[80:95]
    ds_read_b64_tr_b16 v[18:19], v10 offset:13312
    ds_read_b64_tr_b16 v[20:21], v11 offset:12288
    s_waitcnt vmcnt(24)
    s_waitcnt lgkmcnt(1)
    v_mfma_f32_32x32x16_bf16 v[32:47], v[16:19], v[160:163], v[32:47]
    s_lshl_b32 s80, s95, 10
    s_add_u32 s80, s80, s88
    s_add_u32 s95, s95, 1
    s_cmp_eq_u32 s95, s91
    s_cselect_b32 s95, s90, s95
    buffer_load_dwordx4 v[152:155], v4, s[72:75], s80 offen sc1
    s_add_u32 s80, s80, s19
    buffer_load_dwordx4 v[156:159], v4, s[72:75], s80 offen sc1
    v_mfma_f32_32x32x16_bf16 v[64:79], v[16:19], v[164:167], v[64:79]
    ds_read_b64_tr_b16 v[22:23], v11 offset:13312
    ds_read_b64_tr_b16 v[24:25], v10 offset:14336
    s_waitcnt lgkmcnt(1)
    v_mfma_f32_32x32x16_bf16 v[48:63], v[20:23], v[160:163], v[48:63]
    s_sub_u32 s80, s8, s28
    s_lshl_b32 s80, s80, 4
    s_add_u32 m0, s78, 12288
    s_nop 0
    buffer_load_dwordx4 v13, s[48:51], s80 offen lds
    buffer_load_dwordx4 v14, s[48:51], s80 offen offset:1024 lds
    v_mfma_f32_32x32x16_bf16 v[80:95], v[20:23], v[164:167], v[80:95]
    ds_read_b64_tr_b16 v[26:27], v10 offset:15360
    ds_read_b64_tr_b16 v[28:29], v11 offset:14336
    s_waitcnt vmcnt(26)
    s_waitcnt lgkmcnt(1)
    v_mfma_f32_32x32x16_bf16 v[32:47], v[24:27], v[168:171], v[32:47]
    s_lshl_b32 s80, s95, 10
    s_add_u32 s80, s80, s88
    s_add_u32 s95, s95, 1
    s_cmp_eq_u32 s95, s91
    s_cselect_b32 s95, s90, s95
    buffer_load_dwordx4 v[160:163], v4, s[72:75], s80 offen sc1
    s_add_u32 s80, s80, s19
    buffer_load_dwordx4 v[164:167], v4, s[72:75], s80 offen sc1
    v_mfma_f32_32x32x16_bf16 v[64:79], v[24:27], v[172:175], v[64:79]
    ds_read_b64_tr_b16 v[30:31], v11 offset:15360
    ds_read_b64_tr_b16 v[16:17], v10 offset:16384
    s_waitcnt lgkmcnt(1)
    v_mfma_f32_32x32x16_bf16 v[48:63], v[28:31], v[168:171], v[48:63]
    s_sub_u32 s80, s9, s28
    s_lshl_b32 s80, s80, 4
    s_add_u32 m0, s78, 14336
    s_nop 0
    buffer_load_dwordx4 v13, s[48:51], s80 offen lds
    buffer_load_dwordx4 v14, s[48:51], s80 offen offset:1024 lds
    v_mfma_f32_32x32x16_bf16 v[80:95], v[28:31], v[172:175], v[80:95]
    ds_read_b64_tr_b16 v[18:19], v10 offset:17408
    ds_read_b64_tr_b16 v[20:21], v11 offset:16384
    ds_read_b64_tr_b16 v[22:23], v11 offset:17408
    s_waitcnt vmcnt(28)
    s_waitcnt lgkmcnt(0)
    ds_read_b64_tr_b16 v[24:25], v10 offset:18432
    ds_read_b64_tr_b16 v[26:27], v10 offset:19456
    ds_read_b64_tr_b16 v[28:29], v11 offset:18432
    ds_read_b64_tr_b16 v[30:31], v11 offset:19456
    v_mfma_f32_32x32x16_bf16 v[32:47], v[16:19], v[176:179], v[32:47]
    ds_read_b64_tr_b16 v[192:193], v10 offset:20480
    ds_read_b64_tr_b16 v[194:195], v10 offset:21504
    ds_read_b64_tr_b16 v[196:197], v11 offset:20480
    ds_read_b64_tr_b16 v[198:199], v11 offset:21504
    v_mfma_f32_32x32x16_bf16 v[48:63], v[20:23], v[176:179], v[48:63]
    s_lshl_b32 s80, s95, 10
    s_add_u32 s80, s80, s88
    s_add_u32 s95, s95, 1
    s_cmp_eq_u32 s95, s91
    s_cselect_b32 s95, s90, s95
    buffer_load_dwordx4 v[168:171], v4, s[72:75], s80 offen sc1
    s_add_u32 s80, s80, s19
    buffer_load_dwordx4 v[172:175], v4, s[72:75], s80 offen sc1
    v_mfma_f32_32x32x16_bf16 v[64:79], v[16:19], v[180:183], v[64:79]
    s_sub_u32 s80, s10, s28
    s_lshl_b32 s80, s80, 4
    s_add_u32 m0, s78, 16384
    s_nop 0
    buffer_load_dwordx4 v13, s[48:51], s80 offen lds
    buffer_load_dwordx4 v14, s[48:51], s80 offen offset:1024 lds
    v_mfma_f32_32x32x16_bf16 v[80:95], v[20:23], v[180:183], v[80:95]
    s_waitcnt vmcnt(30)
    s_waitcnt lgkmcnt(4)
    v_mfma_f32_32x32x16_bf16 v[32:47], v[24:27], v[184:187], v[32:47]
    ds_read_b64_tr_b16 v[200:201], v10 offset:22528
    ds_read_b64_tr_b16 v[202:203], v10 offset:23552
    ds_read_b64_tr_b16 v[204:205], v11 offset:22528
    ds_read_b64_tr_b16 v[206:207], v11 offset:23552
    v_mfma_f32_32x32x16_bf16 v[48:63], v[28:31], v[184:187], v[48:63]
    v_mfma_f32_32x32x16_bf16 v[64:79], v[24:27], v[188:191], v[64:79]
    s_sub_u32 s80, s11, s28
    s_lshl_b32 s80, s80, 4
    s_add_u32 m0, s78, 18432
    s_nop 0
    buffer_load_dwordx4 v13, s[48:51], s80 offen lds
    buffer_load_dwordx4 v14, s[48:51], s80 offen offset:1024 lds
    v_mfma_f32_32x32x16_bf16 v[80:95], v[28:31], v[188:191], v[80:95]
    s_waitcnt vmcnt(30)
    s_waitcnt lgkmcnt(4)
    v_mfma_f32_32x32x16_bf16 v[32:47], v[192:195], v[96:99], v[32:47]
    ds_read_b64_tr_b16 v[16:17], v10 offset:26784
    ds_read_b64_tr_b16 v[18:19], v10 offset:27808
    ds_read_b64_tr_b16 v[20:21], v11 offset:26784
    ds_read_b64_tr_b16 v[22:23], v11 offset:27808
    v_mfma_f32_32x32x16_bf16 v[48:63], v[196:199], v[96:99], v[48:63]
    v_mfma_f32_32x32x16_bf16 v[64:79], v[192:195], v[100:103], v[64:79]
    s_sub_u32 s80, s12, s28
    s_lshl_b32 s80, s80, 4
    s_add_u32 m0, s78, 20480
    s_nop 0
    buffer_load_dwordx4 v13, s[48:51], s80 offen lds
    buffer_load_dwordx4 v14, s[48:51], s80 offen offset:1024 lds
    v_mfma_f32_32x32x16_bf16 v[80:95], v[196:199], v[100:103], v[80:95]
    s_waitcnt vmcnt(30)
    s_waitcnt lgkmcnt(4)
    v_mfma_f32_32x32x16_bf16 v[32:47], v[200:203], v[104:107], v[32:47]
    ds_read_b64_tr_b16 v[24:25], v10 offset:28832
    ds_read_b64_tr_b16 v[26:27], v10 offset:29856
    ds_read_b64_tr_b16 v[28:29], v11 offset:28832
    ds_read_b64_tr_b16 v[30:31], v11 offset:29856
    v_mfma_f32_32x32x16_bf16 v[48:63], v[204:207], v[104:107], v[48:63]
    v_mfma_f32_32x32x16_bf16 v[64:79], v[200:203], v[108:111], v[64:79]
    s_sub_u32 s80, s13, s28
    s_lshl_b32 s80, s80, 4
    s_add_u32 m0, s78, 22528
    s_nop 0
    buffer_load_dwordx4 v13, s[48:51], s80 offen lds
    buffer_load_dwordx4 v14, s[48:51], s80 offen offset:1024 lds
    v_mfma_f32_32x32x16_bf16 v[80:95], v[204:207], v[108:111], v[80:95]
    s_waitcnt vmcnt(30)
    s_waitcnt lgkmcnt(4)
    v_mfma_f32_32x32x16_bf16 v[32:47], v[16:19], v[112:115], v[32:47]
    s_waitcnt vmcnt(18)
    ds_read_b64_tr_b16 v[176:177], v10 offset:10240
    ds_read_b64_tr_b16 v[178:179], v10 offset:11264
    ds_read_b64_tr_b16 v[180:181], v11 offset:10240
    ds_read_b64_tr_b16 v[182:183], v11 offset:11264
    v_mfma_f32_32x32x16_bf16 v[48:63], v[20:23], v[112:115], v[48:63]
    v_mfma_f32_32x32x16_bf16 v[64:79], v[16:19], v[116:119], v[64:79]
    s_sub_u32 s80, s14, s28
    s_lshl_b32 s80, s80, 4
    s_add_u32 m0, s78, 26784
    s_nop 0
    buffer_load_dwordx4 v13, s[48:51], s80 offen lds
    buffer_load_dwordx4 v14, s[48:51], s80 offen offset:1024 lds
    v_mfma_f32_32x32x16_bf16 v[80:95], v[20:23], v[116:119], v[80:95]
    s_waitcnt lgkmcnt(4)
    v_mfma_f32_32x32x16_bf16 v[32:47], v[24:27], v[120:123], v[32:47]
    ds_read_b64_tr_b16 v[184:185], v10 offset:0
    ds_read_b64_tr_b16 v[186:187], v10 offset:1024
    ds_read_b64_tr_b16 v[188:189], v11 offset:0
    ds_read_b64_tr_b16 v[190:191], v11 offset:1024
    v_mfma_f32_32x32x16_bf16 v[48:63], v[28:31], v[120:123], v[48:63]
    v_mfma_f32_32x32x16_bf16 v[64:79], v[24:27], v[124:127], v[64:79]
    s_sub_u32 s80, s15, s28
    s_lshl_b32 s80, s80, 4
    s_add_u32 m0, s78, 28832
    s_nop 0
    buffer_load_dwordx4 v13, s[48:51], s80 offen lds
    buffer_load_dwordx4 v14, s[48:51], s80 offen offset:1024 lds
    v_mfma_f32_32x32x16_bf16 v[80:95], v[28:31], v[124:127], v[80:95]
L_G_tail:
    ds_read_b32 v3, v1 offset:60
    s_waitcnt lgkmcnt(0)
    s_setprio 2
    v_readfirstlane_b32 s84, v3
    s_cmp_ge_u32 s84, 4
    s_cbranch_scc0 L_G_await
L_G_aback:
    buffer_load_dwordx4 v[192:195], v4, s[72:75], s8 offen sc1
    s_add_u32 s81, s8, s29
    buffer_load_dwordx4 v[196:199], v4, s[72:75], s81 offen sc1
    buffer_load_dwordx4 v[200:203], v4, s[72:75], s9 offen sc1
    s_add_u32 s81, s9, s29
    buffer_load_dwordx4 v[204:207], v4, s[72:75], s81 offen sc1
    buffer_load_dwordx4 v[208:211], v4, s[72:75], s10 offen sc1
    s_add_u32 s81, s10, s29
    buffer_load_dwordx4 v[212:215], v4, s[72:75], s81 offen sc1
    buffer_load_dwordx4 v[216:219], v4, s[72:75], s11 offen sc1
    s_add_u32 s81, s11, s29
    buffer_load_dwordx4 v[220:223], v4, s[72:75], s81 offen sc1
    s_waitcnt vmcnt(20)
    ds_read_b64_tr_b16 v[16:17], v10 offset:2048
    ds_read_b64_tr_b16 v[18:19], v10 offset:3072
    ds_read_b64_tr_b16 v[20:21], v11 offset:2048
    ds_read_b64_tr_b16 v[22:23], v11 offset:3072
    s_cmp_ge_u32 s6, 2
    s_cbranch_scc1 L_G_skip21
    v_mfma_f32_32x32x16_bf16 v[32:47], v[176:179], v[168:171], v[32:47]
    v_mfma_f32_32x32x16_bf16 v[48:63], v[180:183], v[168:171], v[48:63]
    v_mfma_f32_32x32x16_bf16 v[64:79], v[176:179], v[172:175], v[64:79]
    v_mfma_f32_32x32x16_bf16 v[80:95], v[180:183], v[172:175], v[80:95]
L_G_skip21:
    v_mfma_f32_32x32x16_bf16 v[32:47], v[184:187], v[128:131], v[32:47]
    ds_read_b64_tr_b16 v[24:25], v10 offset:4096
    ds_read_b64_tr_b16 v[26:27], v10 offset:5120
    ds_read_b64_tr_b16 v[28:29], v11 offset:4096
    ds_read_b64_tr_b16 v[30:31], v11 offset:5120
    v_mfma_f32_32x32x16_bf16 v[48:63], v[188:191], v[128:131], v[48:63]
    v_mfma_f32_32x32x16_bf16 v[64:79], v[184:187], v[132:135], v[64:79]
    v_mfma_f32_32x32x16_bf16 v[80:95], v[188:191], v[132:135], v[80:95]
    s_waitcnt lgkmcnt(4)
    v_mfma_f32_32x32x16_bf16 v[32:47], v[16:19], v[136:139], v[32:47]
    ds_read_b64_tr_b16 v[176:177], v10 offset:6144
    ds_read_b64_tr_b16 v[178:179], v10 offset:7168
    ds_read_b64_tr_b16 v[180:181], v11 offset:6144
    ds_read_b64_tr_b16 v[182:183], v11 offset:7168
    v_mfma_f32_32x32x16_bf16 v[48:63], v[20:23], v[136:139], v[48:63]
    v_mfma_f32_32x32x16_bf16 v[64:79], v[16:19], v[140:143], v[64:79]
    v_mfma_f32_32x32x16_bf16 v[80:95], v[20:23], v[140:143], v[80:95]
    s_waitcnt lgkmcnt(4)
    v_mfma_f32_32x32x16_bf16 v[32:47], v[24:27], v[144:147], v[32:47]
    ds_read_b64_tr_b16 v[184:185], v10 offset:8192
    ds_read_b64_tr_b16 v[186:187], v10 offset:9216
    ds_read_b64_tr_b16 v[188:189], v11 offset:8192
    ds_read_b64_tr_b16 v[190:191], v11 offset:9216
    v_mfma_f32_32x32x16_bf16 v[48:63], v[28:31], v[144:147], v[48:63]
    v_mfma_f32_32x32x16_bf16 v[64:79], v[24:27], v[148:151], v[64:79]
    v_mfma_f32_32x32x16_bf16 v[80:95], v[28:31], v[148:151], v[80:95]
    s_waitcnt lgkmcnt(4)
    v_mfma_f32_32x32x16_bf16 v[32:47], v[176:179], v[152:155], v[32:47]
    ds_read_b64_tr_b16 v[16:17], v10 offset:12288
    ds_read_b64_tr_b16 v[18:19], v10 offset:13312
    ds_read_b64_tr_b16 v[20:21], v11 offset:12288
    ds_read_b64_tr_b16 v[22:23], v11 offset:13312
    v_mfma_f32_32x32x16_bf16 v[48:63], v[180:183], v[152:155], v[48:63]
    buffer_load_dwordx4 v[224:227], v4, s[72:75], s12 offen sc1
    s_add_u32 s81, s12, s29
    buffer_load_dwordx4 v[228:231], v4, s[72:75], s81 offen sc1
    buffer_load_dwordx4 v[232:235], v4, s[72:75], s13 offen sc1
    s_add_u32 s81, s13, s29
    buffer_load_dwordx4 v[236:239], v4, s[72:75], s81 offen sc1
    buffer_load_dwordx4 v[240:243], v4, s[72:75], s14 offen sc1
    s_add_u32 s81, s14, s29
    buffer_load_dwordx4 v[244:247], v4, s[72:75], s81 offen sc1
    buffer_load_dwordx4 v[248:251], v4, s[72:75], s15 offen sc1
    s_add_u32 s81, s15, s29
    buffer_load_dwordx4 v[252:255], v4, s[72:75], s81 offen sc1
    v_mfma_f32_32x32x16_bf16 v[64:79], v[176:179], v[156:159], v[64:79]
    v_mfma_f32_32x32x16_bf16 v[80:95], v[180:183], v[156:159], v[80:95]
    s_waitcnt lgkmcnt(4)
    v_mfma_f32_32x32x16_bf16 v[32:47], v[184:187], v[160:163], v[32:47]
    ds_read_b64_tr_b16 v[24:25], v10 offset:14336
    ds_read_b64_tr_b16 v[26:27], v10 offset:15360
    ds_read_b64_tr_b16 v[28:29], v11 offset:14336
    ds_read_b64_tr_b16 v[30:31], v11 offset:15360
    v_mfma_f32_32x32x16_bf16 v[48:63], v[188:191], v[160:163], v[48:63]
    s_waitcnt vmcnt(14)
    v_max3_u32 v3, v192, v193, v194
    v_max3_u32 v3, v195, v196, v3
    v_max3_u32 v3, v197, v198, v3
    v_max_u32 v3, v199, v3
    v_mfma_f32_32x32x16_bf16 v[64:79], v[184:187], v[164:167], v[64:79]
    v_cmp_eq_u32 vcc, -1, v3
    v_mfma_f32_32x32x16_bf16 v[80:95], v[188:191], v[164:167], v[80:95]
    s_cbranch_vccnz L_ort_101
L_ook_102:
    s_waitcnt lgkmcnt(4)
    v_mfma_f32_32x32x16_bf16 v[32:47], v[16:19], v[192:195], v[32:47]
    ds_read_b64_tr_b16 v[176:177], v10 offset:16384
    ds_read_b64_tr_b16 v[178:179], v10 offset:17408
    ds_read_b64_tr_b16 v[180:181], v11 offset:16384
    ds_read_b64_tr_b16 v[182:183], v11 offset:17408
    v_mfma_f32_32x32x16_bf16 v[48:63], v[20:23], v[192:195], v[48:63]
    s_waitcnt vmcnt(12)
    v_max3_u32 v3, v200, v201, v202
    v_max3_u32 v3, v203, v204, v3
    v_max3_u32 v3, v205, v206, v3
    v_max_u32 v3, v207, v3
    v_mfma_f32_32x32x16_bf16 v[64:79], v[16:19], v[196:199], v[64:79]
    v_cmp_eq_u32 vcc, -1, v3
    v_mfma_f32_32x32x16_bf16 v[80:95], v[20:23], v[196:199], v[80:95]
    s_cbranch_vccnz L_ort_103
L_ook_104:
    s_waitcnt lgkmcnt(4)
    v_mfma_f32_32x32x16_bf16 v[32:47], v[24:27], v[200:203], v[32:47]
    ds_read_b64_tr_b16 v[184:185], v10 offset:18432
    ds_read_b64_tr_b16 v[186:187], v10 offset:19456
    ds_read_b64_tr_b16 v[188:189], v11 offset:18432
    ds_read_b64_tr_b16 v[190:191], v11 offset:19456
    v_mfma_f32_32x32x16_bf16 v[48:63], v[28:31], v[200:203], v[48:63]
    s_waitcnt vmcnt(10)
    v_max3_u32 v3, v208, v209, v210
    v_max3_u32 v3, v211, v212, v3
    v_max3_u32 v3, v213, v214, v3
    v_max_u32 v3, v215, v3
    v_mfma_f32_32x32x16_bf16 v[64:79], v[24:27], v[204:207], v[64:79]
    v_cmp_eq_u32 vcc, -1, v3
    v_mfma_f32_32x32x16_bf16 v[80:95], v[28:31], v[204:207], v[80:95]
    s_cbranch_vccnz L_ort_105
L_ook_106:
    s_waitcnt lgkmcnt(4)
    v_mfma_f32_32x32x16_bf16 v[32:47], v[176:179], v[208:211], v[32:47]
    ds_read_b64_tr_b16 v[16:17], v10 offset:20480
    ds_read_b64_tr_b16 v[18:19], v10 offset:21504
    ds_read_b64_tr_b16 v[20:21], v11 offset:20480
    ds_read_b64_tr_b16 v[22:23], v11 offset:21504
    v_mfma_f32_32x32x16_bf16 v[48:63], v[180:183], v[208:211], v[48:63]
    s_waitcnt vmcnt(8)
    v_max3_u32 v3, v216, v217, v218
    v_max3_u32 v3, v219, v220, v3
    v_max3_u32 v3, v221, v222, v3
    v_max_u32 v3, v223, v3
    v_mfma_f32_32x32x16_bf16 v[64:79], v[176:179], v[212:215], v[64:79]
    v_cmp_eq_u32 vcc, -1, v3
    v_mfma_f32_32x32x16_bf16 v[80:95], v[180:183], v[212:215], v[80:95]
    s_cbranch_vccnz L_ort_107
L_ook_108:
    s_waitcnt lgkmcnt(4)
    v_mfma_f32_32x32x16_bf16 v[32:47], v[184:187], v[216:219], v[32:47]
    ds_read_b64_tr_b16 v[24:25], v10 offset:22528
    ds_read_b64_tr_b16 v[26:27], v10 offset:23552
    ds_read_b64_tr_b16 v[28:29], v11 offset:22528
    ds_read_b64_tr_b16 v[30:31], v11 offset:23552
    v_mfma_f32_32x32x16_bf16 v[48:63], v[188:191], v[216:219], v[48:63]
    s_waitcnt vmcnt(6)
    v_max3_u32 v3, v224, v225, v226
    v_max3_u32 v3, v227, v228, v3
    v_max3_u32 v3, v229, v230, v3
    v_max_u32 v3, v231, v3
    v_mfma_f32_32x32x16_bf16 v[64:79], v[184:187], v[220:223], v[64:79]
    v_cmp_eq_u32 vcc, -1, v3
    v_mfma_f32_32x32x16_bf16 v[80:95], v[188:191], v[220:223], v[80:95]
    s_cbranch_vccnz L_ort_109
L_ook_110:
    s_waitcnt lgkmcnt(4)
    v_mfma_f32_32x32x16_bf16 v[32:47], v[16:19], v[224:227], v[32:47]
    ds_read_b64_tr_b16 v[176:177], v10 offset:26784
    ds_read_b64_tr_b16 v[178:179], v10 offset:27808
    ds_read_b64_tr_b16 v[180:181], v11 offset:26784
    ds_read_b64_tr_b16 v[182:183], v11 offset:27808
    v_mfma_f32_32x32x16_bf16 v[48:63], v[20:23], v[224:227], v[48:63]
    s_waitcnt vmcnt(4)
    v_max3_u32 v3, v232, v233, v234
    v_max3_u32 v3, v235, v236, v3
    v_max3_u32 v3, v237, v238, v3
    v_max_u32 v3, v239, v3
    v_mfma_f32_32x32x16_bf16 v[64:79], v[16:19], v[228:231], v[64:79]
    v_cmp_eq_u32 vcc, -1, v3
    v_mfma_f32_32x32x16_bf16 v[80:95], v[20:23], v[228:231], v[80:95]
    s_cbranch_vccnz L_ort_111
L_ook_112:
    s_waitcnt lgkmcnt(4)
    v_mfma_f32_32x32x16_bf16 v[32:47], v[24:27], v[232:235], v[32:47]
    ds_read_b64_tr_b16 v[184:185], v10 offset:28832
    ds_read_b64_tr_b16 v[186:187], v10 offset:29856
    ds_read_b64_tr_b16 v[188:189], v11 offset:28832
    ds_read_b64_tr_b16 v[190:191], v11 offset:29856
    v_mfma_f32_32x32x16_bf16 v[48:63], v[28:31], v[232:235], v[48:63]
    s_waitcnt vmcnt(2)
    v_max3_u32 v3, v240, v241, v242
    v_max3_u32 v3, v243, v244, v3
    v_max3_u32 v3, v245, v246, v3
    v_max_u32 v3, v247, v3
    v_mfma_f32_32x32x16_bf16 v[64:79], v[24:27], v[236:239], v[64:79]
    v_cmp_eq_u32 vcc, -1, v3
    v_mfma_f32_32x32x16_bf16 v[80:95], v[28:31], v[236:239], v[80:95]
    s_cbranch_vccnz L_ort_113
L_ook_114:
    s_waitcnt lgkmcnt(4)
    v_mfma_f32_32x32x16_bf16 v[32:47], v[176:179], v[240:243], v[32:47]
    v_mfma_f32_32x32x16_bf16 v[48:63], v[180:183], v[240:243], v[48:63]
    s_waitcnt vmcnt(0)
    v_max3_u32 v3, v248, v249, v250
    v_max3_u32 v3, v251, v252, v3
    v_max3_u32 v3, v253, v254, v3
    v_max_u32 v3, v255, v3
    v_mfma_f32_32x32x16_bf16 v[64:79], v[176:179], v[244:247], v[64:79]
    v_cmp_eq_u32 vcc, -1, v3
    v_mfma_f32_32x32x16_bf16 v[80:95], v[180:183], v[244:247], v[80:95]
    s_cbranch_vccnz L_ort_115
L_ook_116:
    s_waitcnt lgkmcnt(0)
    v_mfma_f32_32x32x16_bf16 v[48:63], v[188:191], v[248:251], v[48:63]
    v_mfma_f32_32x32x16_bf16 v[64:79], v[184:187], v[252:255], v[64:79]
    v_mfma_f32_32x32x16_bf16 v[80:95], v[188:191], v[252:255], v[80:95]
    v_mfma_f32_32x32x16_bf16 v[32:47], v[184:187], v[248:251], v[32:47]
    s_nop 8
    ds_write_b128 v8, v[48:51] offset:4096
    ds_write_b128 v8, v[52:55] offset:5120
    ds_write_b128 v8, v[56:59] offset:6144
    ds_write_b128 v8, v[60:63] offset:7168
    ds_write_b128 v8, v[64:67] offset:8192
    ds_write_b128 v8, v[68:71] offset:9216
    ds_write_b128 v8, v[72:75] offset:10240
    ds_write_b128 v8, v[76:79] offset:11264
    ds_write_b128 v8, v[80:83] offset:12288
    ds_write_b128 v8, v[84:87] offset:13312
    ds_write_b128 v8, v[88:91] offset:14336
    ds_write_b128 v8, v[92:95] offset:15360
    ds_add_u32 v1, v2 offset:12
    ds_read_b32 v3, v1 offset:12
    s_waitcnt lgkmcnt(0)
    v_readfirstlane_b32 s84, v3
    s_cmp_ge_u32 s84, 4
    s_cbranch_scc0 L_spin_118
L_ok_117:
    ds_read_b128 v[144:147], v5 offset:4096
    ds_read_b128 v[148:151], v5 offset:5120
    ds_read_b128 v[152:155], v5 offset:6144
    ds_read_b128 v[156:159], v5 offset:7168
    ds_read_b128 v[160:163], v6 offset:8192
    ds_read_b128 v[164:167], v6 offset:9216
    ds_read_b128 v[168:171], v6 offset:10240
    ds_read_b128 v[172:175], v6 offset:11264
    ds_read_b128 v[176:179], v7 offset:12288
    ds_read_b128 v[180:183], v7 offset:13312
    ds_read_b128 v[184:187], v7 offset:14336
    ds_read_b128 v[188:191], v7 offset:15360
    s_waitcnt lgkmcnt(8)
    v_pk_add_f32 v[32:33], v[32:33], v[144:145]
    v_pk_add_f32 v[34:35], v[34:35], v[146:147]
    v_pk_add_f32 v[36:37], v[36:37], v[148:149]
    v_pk_add_f32 v[38:39], v[38:39], v[150:151]
    v_pk_add_f32 v[40:41], v[40:41], v[152:153]
    v_pk_add_f32 v[42:43], v[42:43], v[154:155]
    v_pk_add_f32 v[44:45], v[44:45], v[156:157]
    v_pk_add_f32 v[46:47], v[46:47], v[158:159]
    s_waitcnt lgkmcnt(4)
    v_pk_add_f32 v[32:33], v[32:33], v[160:161]
    v_pk_add_f32 v[34:35], v[34:35], v[162:163]
    v_pk_add_f32 v[36:37], v[36:37], v[164:165]
    v_pk_add_f32 v[38:39], v[38:39], v[166:167]
    v_pk_add_f32 v[40:41], v[40:41], v[168:169]
    v_pk_add_f32 v[42:43], v[42:43], v[170:171]
    v_pk_add_f32 v[44:45], v[44:45], v[172:173]
    v_pk_add_f32 v[46:47], v[46:47], v[174:175]
    s_waitcnt lgkmcnt(0)
    v_pk_add_f32 v[32:33], v[32:33], v[176:177]
    v_pk_add_f32 v[34:35], v[34:35], v[178:179]
    v_pk_add_f32 v[36:37], v[36:37], v[180:181]
    v_pk_add_f32 v[38:39], v[38:39], v[182:183]
    v_pk_add_f32 v[40:41], v[40:41], v[184:185]
    v_pk_add_f32 v[42:43], v[42:43], v[186:187]
    v_pk_add_f32 v[44:45], v[44:45], v[188:189]
    v_pk_add_f32 v[46:47], v[46:47], v[190:191]
    v_cvt_pk_bf16_f32 v128, v32, v33
    v_cvt_pk_bf16_f32 v129, v34, v35
    v_cvt_pk_bf16_f32 v130, v36, v37
    v_cvt_pk_bf16_f32 v131, v38, v39
    v_cvt_pk_bf16_f32 v132, v40, v41
    v_cvt_pk_bf16_f32 v133, v42, v43
    v_cvt_pk_bf16_f32 v134, v44, v45
    v_cvt_pk_bf16_f32 v135, v46, v47
    s_nop 1
    v_permlane32_swap_b32 v128, v130
    v_permlane32_swap_b32 v129, v131
    v_permlane32_swap_b32 v132, v134
    v_permlane32_swap_b32 v133, v135
    buffer_store_dwordx4 v[128:131], v9, s[68:71], s86 offen
    buffer_store_dwordx4 v[132:135], v9, s[68:71], s86 offen offset:32
    s_endpgm
L_A:
    s_mov_b32 s83, 0x200000
    v_lshlrev_b32 v3, 2, v0
    v_add_u32 v1, 161152, v3
    v_mov_b32 v2, 161024
    s_mov_b64 exec, 1
    v_mov_b32 v1, v2
    s_mov_b64 exec, -1
    v_mov_b32 v2, 1
    s_lshl_b32 s79, s6, 2
    s_add_u32 s79, s79, 80
    v_add_u32 v5, s79, v1
    s_cmp_lg_u32 s6, 0
    s_cbranch_scc1 L_A_nz
    v_add_u32 v3, 161024, v3
    v_mov_b32 v6, 0
    ds_write_b32 v3, v6
L_A_nz:
    v_add_u32 v18, 14336, v16
    v_add_u32 v19, 14336, v17
    s_mov_b32 s88, s101
    s_mov_b32 s89, 24576
    s_waitcnt lgkmcnt(0)
    s_load_dwordx2 s[76:77], s[32:33], 0
    s_mov_b32 s36, s8
    s_mov_b32 s37, s9
    s_mov_b32 s38, 2097152
    s_mov_b32 s39, 0x20000
    s_mov_b32 s40, s10
    s_mov_b32 s41, s11
    s_mov_b32 s42, 524288
    s_mov_b32 s43, 0x20000
    s_lshl_b32 s79, s101, 2
    s_add_u32 s79, s79, s6
    s_lshl_b32 s79, s79, 14
    s_lshr_b32 s80, s5, 1
    s_lshl_b32 s80, s80, 7
    s_add_u32 s85, s79, s80
    v_and_b32 v176, 15, v0
    v_lshlrev_b32 v176, 10, v176
    v_lshrrev_b32 v13, 2, v0
    v_lshlrev_b32 v13, 10, v13
    v_and_b32 v3, 3, v0
    v_lshl_add_u32 v13, v3, 4, v13
    s_lshl_b32 s79, s5, 6
    v_add_u32 v13, s79, v13
    s_mov_b32 s90, s78
    s_cmp_eq_u32 s100, 0
    s_cbranch_scc1 L_A_xfull
    s_xor_b32 s80, s34, 1
    s_lshl_b32 s79, s80, 11
    s_add_u32 s90, s78, s79
    s_lshl_b32 s79, s80, 14
    s_add_u32 s35, s35, s79
L_A_xfull:
    s_barrier
    buffer_load_dword v177, v176, s[40:43], s85 offen
    s_mov_b32 s87, 2
L_A_xa:
    s_lshl_b32 s81, s88, 7
    s_add_u32 m0, s90, s89
    s_add_u32 s81, s81, s35
    s_cmp_lg_u32 s100, 0
    buffer_load_dwordx4 v16, s[36:39], s81 offen lds
    buffer_load_dwordx4 v17, s[36:39], s81 offen offset:1024 lds
    s_cbranch_scc1 L_A_xsa
    buffer_load_dwordx4 v18, s[36:39], s81 offen offset:2048 lds
    buffer_load_dwordx4 v19, s[36:39], s81 offen offset:3072 lds
L_A_xsa:
    s_add_u32 s88, s88, 1
    s_and_b32 s88, s88, 7
    s_add_u32 s89, s89, 4096
    s_and_b32 s89, s89, 0x7fff
    s_sub_u32 s87, s87, 1
    s_cmp_lg_u32 s87, 0
    s_cbranch_scc1 L_A_xa
    s_mul_i32 s79, s6, 3
    s_lshl_b32 s80, s101, 2
    s_add_u32 s80, s80, s79
    s_lshl_b32 s79, s79, 10
    s_add_u32 s81, s80, 0
    s_and_b32 s81, s81, 31
    s_add_u32 m0, s79, 147712
    s_lshl_b32 s81, s81, 14
    buffer_load_dwordx4 v13, s[40:43], s81 offen lds
    s_add_u32 s81, s80, 1
    s_and_b32 s81, s81, 31
    s_add_u32 m0, s79, 148736
    s_lshl_b32 s81, s81, 14
    buffer_load_dwordx4 v13, s[40:43], s81 offen lds
    s_add_u32 s81, s80, 2
    s_and_b32 s81, s81, 31
    s_add_u32 m0, s79, 149760
    s_lshl_b32 s81, s81, 14
    buffer_load_dwordx4 v13, s[40:43], s81 offen lds
    s_mov_b32 s87, 2
L_A_xb:
    s_lshl_b32 s81, s88, 7
    s_add_u32 m0, s90, s89
    s_add_u32 s81, s81, s35
    s_cmp_lg_u32 s100, 0
    buffer_load_dwordx4 v16, s[36:39], s81 offen lds
    buffer_load_dwordx4 v17, s[36:39], s81 offen offset:1024 lds
    s_cbranch_scc1 L_A_xsb
    buffer_load_dwordx4 v18, s[36:39], s81 offen offset:2048 lds
    buffer_load_dwordx4 v19, s[36:39], s81 offen offset:3072 lds
L_A_xsb:
    s_add_u32 s88, s88, 1
    s_and_b32 s88, s88, 7
    s_add_u32 s89, s89, 4096
    s_and_b32 s89, s89, 0x7fff
    s_sub_u32 s87, s87, 1
    s_cmp_lg_u32 s87, 0
    s_cbranch_scc1 L_A_xb
    s_mov_b32 s72, s32
    s_mov_b32 s73, s33
    s_mov_b32 s74, 8781824
    s_mov_b32 s75, 0x20000
    s_add_u32 s44, s32, 327680
    s_addc_u32 s45, s33, 0
    s_mov_b32 s46, 131072
    s_mov_b32 s47, 0x20000
    v_add_u32 v128, 131072, v4
    v_mov_b32 v129, v4
    v_add_u32 v130, 65536, v4
    v_and_b32 v176, 15, v0
    v_lshrrev_b32 v3, 5, v0
    v_lshl_add_u32 v176, v3, 4, v176
    v_lshlrev_b32 v176, 4, v176
    v_add_u32 v132, 1024, v176
    v_add_u32 v135, 1536, v176
    s_mov_b32 exec_lo, 0xffff0000
    s_mov_b32 exec_hi, 0xffff0000
    v_mov_b32 v132, 2064
    v_mov_b32 v135, 2064
    s_mov_b32 exec_lo, 0x00110000
    s_mov_b32 exec_hi, 0x00110000
    v_mov_b32 v132, 2048
    v_mov_b32 v135, 2048
    s_mov_b64 exec, -1
    v_add_u32 v131, 131072, v132
    v_add_u32 v133, 65536, v132
    v_add_u32 v134, 131072, v135
    v_add_u32 v136, 65536, v135
    s_mul_i32 s79, s6, 2080
    s_add_u32 s8, s79, 131072
    s_add_u32 s9, s79, 139392
    s_add_u32 s10, s79, 147712
    s_add_u32 s11, s78, 24704
    s_and_b32 s79, s2, 7
    s_lshl_b32 s80, s79, 1
    s_lshl_b32 s79, s79, 3
    s_add_u32 s79, s79, s6
    s_lshl_b32 s86, s79, 11
    v_lshrrev_b32 v179, 2, v0
    v_and_b32 v178, 3, v179
    v_add_u32 v178, s80, v178
    v_and_b32 v178, 15, v178
    v_and_b32 v3, 3, v0
    v_lshl_add_u32 v178, v178, 4, v3
    v_lshlrev_b32 v178, 7, v178
    v_lshl_add_u32 v179, v179, 4, v3
    v_lshlrev_b32 v179, 7, v179
    v_mov_b32 v144, 0
    v_mov_b32 v160, 0
    v_mov_b32 v145, 0
    v_mov_b32 v161, 0
    v_mov_b32 v146, 0
    v_mov_b32 v162, 0
    v_mov_b32 v147, 0
    v_mov_b32 v163, 0
    v_mov_b32 v148, 0
    v_mov_b32 v164, 0
    v_mov_b32 v149, 0
    v_mov_b32 v165, 0
    v_mov_b32 v150, 0
    v_mov_b32 v166, 0
    v_mov_b32 v151, 0
    v_mov_b32 v167, 0
    v_mov_b32 v152, 0
    v_mov_b32 v168, 0
    v_mov_b32 v153, 0
    v_mov_b32 v169, 0
    v_mov_b32 v154, 0
    v_mov_b32 v170, 0
    v_mov_b32 v155, 0
    v_mov_b32 v171, 0
    v_mov_b32 v156, 0
    v_mov_b32 v172, 0
    v_mov_b32 v157, 0
    v_mov_b32 v173, 0
    v_mov_b32 v158, 0
    v_mov_b32 v174, 0
    v_mov_b32 v159, 0
    v_mov_b32 v175, 0
    v_mov_b32 v232, 0
    v_mov_b32 v233, 0
    v_mov_b32 v234, 0
    v_mov_b32 v235, 0
    v_mov_b32 v236, 0
    v_mov_b32 v237, 0
    v_mov_b32 v238, 0
    v_mov_b32 v239, 0
    v_mov_b32 v68, 0
    v_mov_b32 v69, 0
    v_mov_b32 v70, 0
    v_mov_b32 v71, 0
    v_mov_b32 v112, 0xdddddddd
    v_mov_b32 v180, 0
    v_mov_b32 v181, 0
    v_mov_b32 v182, 0
    v_mov_b32 v183, 0
    s_mov_b64 exec, 1
    v_mov_b32 v180, 0x3f803f80
    v_mov_b32 v181, 0x3f803f80
    v_mov_b32 v182, 0x3f803f80
    v_mov_b32 v183, 0x3f803f80
    s_mov_b64 exec, -1
    s_lshl_b32 s18, s6, 9
    s_add_u32 s18, s18, 4096
    s_lshl_b32 s19, s7, 5
    s_lshl_b32 s79, s5, 1
    s_add_u32 s19, s19, s79
    s_lshl_b32 s19, s19, 10
    s_add_u32 s19, s19, 1048576
    v_mov_b32 v104, -1
    v_mov_b32 v105, -1
    v_mov_b32 v106, -1
    v_mov_b32 v107, -1
    v_add_u32 v187, s78, v4
    v_and_b32 v14, 31, v0
    v_lshlrev_b32 v14, 2, v14
    v_and_b32 v189, 1, v0
    v_lshlrev_b32 v189, 8, v189
    s_lshl_b32 s30, s7, 9
    s_add_u32 s30, s30, 229376
    s_lshl_b32 s23, s7, 7
    s_add_u32 s23, s23, 262144
    s_cmp_lg_u32 s100, 0
    s_cbranch_scc1 L_lh_119
    s_waitcnt vmcnt(11)
    s_branch L_lj_120
L_lh_119:
    s_waitcnt vmcnt(7)
L_lj_120:
    ds_add_u32 v5, v2 offset:24
    ds_read_b32 v3, v5 offset:0
    s_waitcnt lgkmcnt(0)
    v_readfirstlane_b32 s84, v3
    s_cmp_ge_u32 s84, 1
    s_cbranch_scc0 L_spin_122
L_ok_121:
    s_add_u32 s76, s76, 1
    s_addc_u32 s77, s77, 0
    v_mov_b32 v6, s76
    v_mov_b32 v7, s77
    s_mul_i32 s80, s6, 5
    s_lshl_b32 s79, s101, 2
    s_add_u32 s80, s80, s79
    s_add_u32 s81, s80, 12
    s_and_b32 s81, s81, 31
    s_add_u32 m0, s78, 24704
    s_lshl_b32 s81, s81, 14
    buffer_load_dwordx4 v13, s[40:43], s81 offen lds
    s_add_u32 s81, s80, 13
    s_and_b32 s81, s81, 31
    s_add_u32 m0, s78, 25728
    s_lshl_b32 s81, s81, 14
    buffer_load_dwordx4 v13, s[40:43], s81 offen lds
    s_add_u32 s81, s80, 14
    s_and_b32 s81, s81, 31
    s_add_u32 m0, s78, 26752
    s_lshl_b32 s81, s81, 14
    buffer_load_dwordx4 v13, s[40:43], s81 offen lds
    s_add_u32 s81, s80, 15
    s_and_b32 s81, s81, 31
    s_add_u32 m0, s78, 27776
    s_lshl_b32 s81, s81, 14
    buffer_load_dwordx4 v13, s[40:43], s81 offen lds
    s_add_u32 s81, s80, 16
    s_and_b32 s81, s81, 31
    s_add_u32 m0, s78, 28800
    s_lshl_b32 s81, s81, 14
    buffer_load_dwordx4 v13, s[40:43], s81 offen lds
    s_cmp_lg_u32 s100, 0
    s_cbranch_scc1 L_lh_123
    s_waitcnt vmcnt(13)
    s_branch L_lj_124
L_lh_123:
    s_waitcnt vmcnt(9)
L_lj_124:
    ds_add_u32 v1, v2 offset:0
    s_mov_b32 s87, 2
L_A_xc:
    s_lshl_b32 s81, s88, 7
    s_add_u32 m0, s90, s89
    s_add_u32 s81, s81, s35
    s_cmp_lg_u32 s100, 0
    buffer_load_dwordx4 v16, s[36:39], s81 offen lds
    buffer_load_dwordx4 v17, s[36:39], s81 offen offset:1024 lds
    s_cbranch_scc1 L_A_xsc
    buffer_load_dwordx4 v18, s[36:39], s81 offen offset:2048 lds
    buffer_load_dwordx4 v19, s[36:39], s81 offen offset:3072 lds
L_A_xsc:
    s_add_u32 s88, s88, 1
    s_and_b32 s88, s88, 7
    s_add_u32 s89, s89, 4096
    s_and_b32 s89, s89, 0x7fff
    s_sub_u32 s87, s87, 1
    s_cmp_lg_u32 s87, 0
    s_cbranch_scc1 L_A_xc
    s_cmp_lg_u32 s100, 0
    s_cbranch_scc1 L_lh_125
    s_waitcnt vmcnt(13)
    s_branch L_lj_126
L_lh_125:
    s_waitcnt vmcnt(9)
L_lj_126:
    ds_add_u32 v5, v2 offset:24
    s_cmp_lg_u32 s100, 0
    s_cbranch_scc1 L_lh_127
    s_waitcnt vmcnt(8)
    s_branch L_lj_128
L_lh_127:
    s_waitcnt vmcnt(4)
L_lj_128:
    ds_add_u32 v1, v2 offset:4
    s_mov_b32 s87, 2
L_A_xd:
    s_lshl_b32 s81, s88, 7
    s_add_u32 m0, s90, s89
    s_add_u32 s81, s81, s35
    s_cmp_lg_u32 s100, 0
    buffer_load_dwordx4 v16, s[36:39], s81 offen lds
    buffer_load_dwordx4 v17, s[36:39], s81 offen offset:1024 lds
    s_cbranch_scc1 L_A_xsd
    buffer_load_dwordx4 v18, s[36:39], s81 offen offset:2048 lds
    buffer_load_dwordx4 v19, s[36:39], s81 offen offset:3072 lds
L_A_xsd:
    s_add_u32 s88, s88, 1
    s_and_b32 s88, s88, 7
    s_add_u32 s89, s89, 4096
    s_and_b32 s89, s89, 0x7fff
    s_sub_u32 s87, s87, 1
    s_cmp_lg_u32 s87, 0
    s_cbranch_scc1 L_A_xd
    buffer_load_dwordx2 v[190:191], v178, s[72:75], s18 offen sc1
    s_cmp_lg_u32 s100, 0
    s_cbranch_scc1 L_lh_129
    s_waitcnt vmcnt(9)
    s_branch L_lj_130
L_lh_129:
    s_waitcnt vmcnt(5)
L_lj_130:
    ds_add_u32 v5, v2 offset:24
    ds_read_b32 v3, v1 offset:120
    s_waitcnt lgkmcnt(0)
    v_readfirstlane_b32 s84, v3
    s_cmp_ge_u32 s84, 1
    s_cbranch_scc0 L_spin_132
L_ok_131:
    s_mov_b64 exec, 3
    v_add_u32 v188, s8, v4
    ds_write_b128 v188, v[180:183] offset:2048
    v_add_u32 v188, s9, v4
    ds_write_b128 v188, v[180:183] offset:2048
    s_mov_b64 exec, -1
    s_waitcnt vmcnt(1)
    ds_add_u32 v5, v2 offset:24
    s_waitcnt vmcnt(0)
    v_cmp_ne_u64 vcc, s[76:77], v[190:191]
    s_cbranch_vccz L_A_seen
L_gp_133:
    buffer_load_dwordx2 v[190:191], v178, s[72:75], s18 offen sc1
    s_waitcnt vmcnt(0)
    v_cmp_ne_u64 vcc, s[76:77], v[190:191]
    s_cbranch_vccz L_gpd_134
    s_sub_u32 s83, s83, 1
    s_cbranch_scc0 L_gp_133
    s_mov_b32 s83, 0
L_gpd_134:
L_A_seen:
    s_mov_b32 m0, s8
    s_nop 0
    buffer_load_dwordx4 v4, s[44:47], s86 offen sc1 lds
    buffer_load_dwordx4 v4, s[44:47], s86 offen offset:1024 sc1 lds
    s_add_u32 s86, s86, 8192
    s_and_b32 s86, s86, 0x1ffff
    s_mov_b32 m0, s9
    s_nop 0
    buffer_load_dwordx4 v4, s[44:47], s86 offen sc1 lds
    buffer_load_dwordx4 v4, s[44:47], s86 offen offset:1024 sc1 lds
    s_add_u32 s86, s86, 8192
    s_and_b32 s86, s86, 0x1ffff
    buffer_store_dwordx4 v[104:107], v4, s[72:75], s19 offen sc1
    buffer_store_dwordx4 v[104:107], v4, s[72:75], s19 offen offset:1024 sc1
    s_waitcnt vmcnt(4)
    ds_add_u32 v1, v2 offset:64
    s_waitcnt vmcnt(2)
    ds_read_b32 v3, v1 offset:64
    s_waitcnt lgkmcnt(0)
    v_readfirstlane_b32 s84, v3
    s_cmp_ge_u32 s84, 4
    s_cbranch_scc0 L_spin_136
L_ok_135:
    ds_read_b128 v[24:27], v128 offset:0
    ds_read_b128 v[28:31], v128 offset:2080
    ds_read_b128 v[40:43], v131 offset:0
    ds_read_b128 v[44:47], v134 offset:0
    s_mov_b32 s85, 4
    s_mov_b32 s87, 4
    s_mov_b32 s14, 8192
    s_mov_b32 s15, 0
    s_mov_b64 vcc, -1
    s_mov_b32 s16, 528482304
    s_mov_b32 s17, 1073741824
    ds_read_b32 v3, v5 offset:0
    s_waitcnt lgkmcnt(0)
    v_readfirstlane_b32 s84, v3
    s_cmp_ge_u32 s84, 2
    s_cbranch_scc0 L_spin_138
L_ok_137:
    s_setprio 1
    ds_read_b128 v[16:19], v187 offset:29824
    ds_read_b128 v[20:23], v187 offset:30848
    s_waitcnt lgkmcnt(0)
    v_mfma_f32_32x32x16_bf16 v[72:87], v[24:27], v[16:19], 0
    s_nop 11
.p2align 6
L_A_loop:
    v_exp_f32 v72, v72
    v_mfma_f32_32x32x16_bf16 v[88:103], v[24:27], v[20:23], 0
    s_waitcnt vmcnt(2)
    s_cbranch_vccnz L_A_first
L_A_s0:
    v_exp_f32 v73, v73
    v_exp_f32 v74, v74
    v_exp_f32 v75, v75
    v_exp_f32 v76, v76
    v_exp_f32 v77, v77
    v_smfmac_f32_32x32x32_bf16 v[160:175], v[68:71], v[232:239], v112
    s_waitcnt lgkmcnt(0)
    v_exp_f32 v78, v78
    v_exp_f32 v79, v79
    v_exp_f32 v80, v80
    v_exp_f32 v81, v81
    v_exp_f32 v82, v82
    v_smfmac_f32_32x32x32_bf16 v[144:159], v[40:43], v[72:79], v112
    ds_add_u32 v1, v2 offset:68
    v_exp_f32 v83, v83
    v_exp_f32 v84, v84
    v_exp_f32 v85, v85
    v_exp_f32 v86, v86
    v_exp_f32 v87, v87
    v_exp_f32 v88, v88
    v_mfma_f32_32x32x16_bf16 v[208:223], v[28:31], v[16:19], 0
    ds_read_b128 v[32:35], v128 offset:4160
    v_exp_f32 v89, v89
    v_exp_f32 v90, v90
    v_exp_f32 v91, v91
    v_exp_f32 v92, v92
    v_exp_f32 v93, v93
    v_smfmac_f32_32x32x32_bf16 v[144:159], v[44:47], v[80:87], v112
    ds_read_b128 v[48:51], v131 offset:2080
    v_exp_f32 v94, v94
    v_exp_f32 v95, v95
    v_exp_f32 v96, v96
    v_exp_f32 v97, v97
    v_exp_f32 v98, v98
    v_smfmac_f32_32x32x32_bf16 v[160:175], v[40:43], v[88:95], v112
    ds_read_b128 v[52:55], v134 offset:2080
    v_exp_f32 v99, v99
    v_exp_f32 v100, v100
    v_exp_f32 v101, v101
    v_exp_f32 v102, v102
    v_exp_f32 v103, v103
    v_exp_f32 v208, v208
    v_mfma_f32_32x32x16_bf16 v[224:239], v[28:31], v[20:23], 0
    s_mov_b32 m0, s11
    v_exp_f32 v209, v209
    v_exp_f32 v210, v210
    v_exp_f32 v211, v211
    v_exp_f32 v212, v212
    v_exp_f32 v213, v213
    v_smfmac_f32_32x32x32_bf16 v[160:175], v[44:47], v[96:103], v112
    s_waitcnt lgkmcnt(0)
    v_exp_f32 v214, v214
    v_exp_f32 v215, v215
    v_exp_f32 v216, v216
    v_exp_f32 v217, v217
    v_exp_f32 v218, v218
    v_smfmac_f32_32x32x32_bf16 v[144:159], v[48:51], v[208:215], v112
    ds_read_b32 v3, v1 offset:68
    v_exp_f32 v219, v219
    v_exp_f32 v220, v220
    v_exp_f32 v221, v221
    v_exp_f32 v222, v222
    v_exp_f32 v223, v223
    v_exp_f32 v224, v224
    v_mfma_f32_32x32x16_bf16 v[72:87], v[32:35], v[16:19], 0
    ds_read_b128 v[36:39], v128 offset:6240
    v_exp_f32 v225, v225
    v_exp_f32 v226, v226
    v_exp_f32 v227, v227
    v_exp_f32 v228, v228
    v_exp_f32 v229, v229
    v_smfmac_f32_32x32x32_bf16 v[144:159], v[52:55], v[216:223], v112
    ds_read_b128 v[56:59], v131 offset:4160
    v_exp_f32 v230, v230
    v_exp_f32 v231, v231
    v_exp_f32 v232, v232
    v_exp_f32 v233, v233
    v_exp_f32 v234, v234
    v_smfmac_f32_32x32x32_bf16 v[160:175], v[48:51], v[224:231], v112
    ds_read_b128 v[60:63], v134 offset:4160
    v_exp_f32 v235, v235
    v_exp_f32 v236, v236
    v_exp_f32 v237, v237
    v_exp_f32 v238, v238
    v_exp_f32 v239, v239
    v_exp_f32 v72, v72
    v_mfma_f32_32x32x16_bf16 v[88:103], v[32:35], v[20:23], 0
    s_add_u32 s86, s86, 8192
    s_and_b32 s86, s86, 0x1ffff
    v_exp_f32 v73, v73
    v_exp_f32 v74, v74
    v_exp_f32 v75, v75
    v_exp_f32 v76, v76
    v_exp_f32 v77, v77
    v_smfmac_f32_32x32x32_bf16 v[160:175], v[52:55], v[232:239], v112
    s_waitcnt lgkmcnt(0)
    v_exp_f32 v78, v78
    v_readfirstlane_b32 s84, v3
    v_exp_f32 v79, v79
    v_exp_f32 v80, v80
    v_exp_f32 v81, v81
    v_exp_f32 v82, v82
    v_smfmac_f32_32x32x32_bf16 v[144:159], v[56:59], v[72:79], v112
    s_cmp_ge_u32 s84, s85
    s_cbranch_scc0 L_spin_140
L_ok_139:
    v_exp_f32 v83, v83
    v_exp_f32 v84, v84
    v_exp_f32 v85, v85
    v_exp_f32 v86, v86
    v_exp_f32 v87, v87
    v_exp_f32 v88, v88
    v_mfma_f32_32x32x16_bf16 v[208:223], v[36:39], v[16:19], 0
    ds_read_b128 v[24:27], v128 offset:8320
    v_exp_f32 v89, v89
    v_exp_f32 v90, v90
    v_exp_f32 v91, v91
    v_exp_f32 v92, v92
    v_exp_f32 v93, v93
    v_smfmac_f32_32x32x32_bf16 v[144:159], v[60:63], v[80:87], v112
    ds_read_b128 v[64:67], v131 offset:6240
    v_exp_f32 v94, v94
    v_exp_f32 v95, v95
    v_exp_f32 v96, v96
    v_exp_f32 v97, v97
    v_exp_f32 v98, v98
    v_smfmac_f32_32x32x32_bf16 v[160:175], v[56:59], v[88:95], v112
    ds_read_b128 v[68:71], v134 offset:6240
    v_exp_f32 v99, v99
    v_exp_f32 v100, v100
    v_exp_f32 v101, v101
    v_exp_f32 v102, v102
    v_exp_f32 v103, v103
    v_exp_f32 v208, v208
    v_mfma_f32_32x32x16_bf16 v[224:239], v[36:39], v[20:23], 0
    s_cbranch_vccnz L_A_nd3
    buffer_load_dwordx4 v4, s[44:47], s86 offen sc1 lds
    buffer_load_dwordx4 v4, s[44:47], s86 offen offset:1024 sc1 lds
L_A_nd3:
    v_exp_f32 v209, v209
    v_exp_f32 v210, v210
    v_exp_f32 v211, v211
    v_exp_f32 v212, v212
    v_exp_f32 v213, v213
    v_smfmac_f32_32x32x32_bf16 v[160:175], v[60:63], v[96:103], v112
    s_waitcnt lgkmcnt(0)
    v_exp_f32 v214, v214
    v_exp_f32 v215, v215
    v_exp_f32 v216, v216
    v_exp_f32 v217, v217
    v_exp_f32 v218, v218
    v_smfmac_f32_32x32x32_bf16 v[144:159], v[64:67], v[208:215], v112
    v_exp_f32 v219, v219
    v_exp_f32 v220, v220
    v_exp_f32 v221, v221
    v_exp_f32 v222, v222
    v_exp_f32 v223, v223
    v_exp_f32 v224, v224
    v_mfma_f32_32x32x16_bf16 v[72:87], v[24:27], v[16:19], 0
    ds_read_b128 v[28:31], v128 offset:10400
    v_exp_f32 v225, v225
    v_exp_f32 v226, v226
    v_exp_f32 v227, v227
    v_exp_f32 v228, v228
    v_exp_f32 v229, v229
    v_smfmac_f32_32x32x32_bf16 v[144:159], v[68:71], v[216:223], v112
    ds_read_b128 v[40:43], v131 offset:8320
    v_exp_f32 v230, v230
    v_exp_f32 v231, v231
    v_exp_f32 v232, v232
    v_exp_f32 v233, v233
    v_exp_f32 v234, v234
    v_smfmac_f32_32x32x32_bf16 v[160:175], v[64:67], v[224:231], v112
    ds_read_b128 v[44:47], v134 offset:8320
    v_exp_f32 v235, v235
    v_exp_f32 v236, v236
    v_exp_f32 v237, v237
    v_exp_f32 v238, v238
    v_exp_f32 v239, v239
    v_exp_f32 v72, v72
    v_mfma_f32_32x32x16_bf16 v[88:103], v[24:27], v[20:23], 0
    s_waitcnt vmcnt(2)
    s_cbranch_vccnz L_A_fchk
L_A_fbk:
    v_exp_f32 v73, v73
    v_exp_f32 v74, v74
    v_exp_f32 v75, v75
    v_exp_f32 v76, v76
    v_exp_f32 v77, v77
    v_smfmac_f32_32x32x32_bf16 v[160:175], v[68:71], v[232:239], v112
    s_waitcnt lgkmcnt(0)
    v_exp_f32 v78, v78
    v_exp_f32 v79, v79
    v_exp_f32 v80, v80
    v_exp_f32 v81, v81
    v_exp_f32 v82, v82
    v_smfmac_f32_32x32x32_bf16 v[144:159], v[40:43], v[72:79], v112
    ds_add_u32 v1, v2 offset:72
    v_exp_f32 v83, v83
    v_exp_f32 v84, v84
    v_exp_f32 v85, v85
    v_exp_f32 v86, v86
    v_exp_f32 v87, v87
    v_exp_f32 v88, v88
    v_mfma_f32_32x32x16_bf16 v[208:223], v[28:31], v[16:19], 0
    ds_read_b128 v[32:35], v128 offset:12480
    v_exp_f32 v89, v89
    v_exp_f32 v90, v90
    v_exp_f32 v91, v91
    v_exp_f32 v92, v92
    v_exp_f32 v93, v93
    v_smfmac_f32_32x32x32_bf16 v[144:159], v[44:47], v[80:87], v112
    ds_read_b128 v[48:51], v131 offset:10400
    v_exp_f32 v94, v94
    v_exp_f32 v95, v95
    v_exp_f32 v96, v96
    v_exp_f32 v97, v97
    v_exp_f32 v98, v98
    v_smfmac_f32_32x32x32_bf16 v[160:175], v[40:43], v[88:95], v112
    ds_read_b128 v[52:55], v134 offset:10400
    v_exp_f32 v99, v99
    v_exp_f32 v100, v100
    v_exp_f32 v101, v101
    v_exp_f32 v102, v102
    v_exp_f32 v103, v103
    v_exp_f32 v208, v208
    v_mfma_f32_32x32x16_bf16 v[224:239], v[28:31], v[20:23], 0
    s_mov_b32 m0, s8
    v_exp_f32 v209, v209
    v_exp_f32 v210, v210
    v_exp_f32 v211, v211
    v_exp_f32 v212, v212
    v_exp_f32 v213, v213
    v_smfmac_f32_32x32x32_bf16 v[160:175], v[44:47], v[96:103], v112
    s_waitcnt lgkmcnt(0)
    v_exp_f32 v214, v214
    v_exp_f32 v215, v215
    v_exp_f32 v216, v216
    v_exp_f32 v217, v217
    v_exp_f32 v218, v218
    v_smfmac_f32_32x32x32_bf16 v[144:159], v[48:51], v[208:215], v112
    ds_read_b32 v3, v1 offset:72
    v_exp_f32 v219, v219
    v_exp_f32 v220, v220
    v_exp_f32 v221, v221
    v_exp_f32 v222, v222
    v_exp_f32 v223, v223
    v_exp_f32 v224, v224
    v_mfma_f32_32x32x16_bf16 v[72:87], v[32:35], v[16:19], 0
    ds_read_b128 v[36:39], v128 offset:14560
    v_exp_f32 v225, v225
    v_exp_f32 v226, v226
    v_exp_f32 v227, v227
    v_exp_f32 v228, v228
    v_exp_f32 v229, v229
    v_smfmac_f32_32x32x32_bf16 v[144:159], v[52:55], v[216:223], v112
    ds_read_b128 v[56:59], v131 offset:12480
    v_exp_f32 v230, v230
    v_exp_f32 v231, v231
    v_exp_f32 v232, v232
    v_exp_f32 v233, v233
    v_exp_f32 v234, v234
    v_smfmac_f32_32x32x32_bf16 v[160:175], v[48:51], v[224:231], v112
    ds_read_b128 v[60:63], v134 offset:12480
    v_exp_f32 v235, v235
    v_exp_f32 v236, v236
    v_exp_f32 v237, v237
    v_exp_f32 v238, v238
    v_exp_f32 v239, v239
    v_exp_f32 v72, v72
    v_mfma_f32_32x32x16_bf16 v[88:103], v[32:35], v[20:23], 0
    s_add_u32 s86, s86, s14
    s_and_b32 s86, s86, 0x1ffff
    v_exp_f32 v73, v73
    v_exp_f32 v74, v74
    v_exp_f32 v75, v75
    v_exp_f32 v76, v76
    v_exp_f32 v77, v77
    v_smfmac_f32_32x32x32_bf16 v[160:175], v[52:55], v[232:239], v112
    s_waitcnt lgkmcnt(0)
    v_exp_f32 v78, v78
    v_readfirstlane_b32 s84, v3
    v_exp_f32 v79, v79
    v_exp_f32 v80, v80
    v_exp_f32 v81, v81
    v_exp_f32 v82, v82
    v_smfmac_f32_32x32x32_bf16 v[144:159], v[56:59], v[72:79], v112
    s_cmp_ge_u32 s84, s85
    s_cbranch_scc0 L_spin_142
L_ok_141:
    v_exp_f32 v83, v83
    v_exp_f32 v84, v84
    v_exp_f32 v85, v85
    v_exp_f32 v86, v86
    v_exp_f32 v87, v87
    v_exp_f32 v88, v88
    v_mfma_f32_32x32x16_bf16 v[208:223], v[36:39], v[16:19], 0
    ds_read_b128 v[24:27], v128 offset:16640
    v_exp_f32 v89, v89
    v_exp_f32 v90, v90
    v_exp_f32 v91, v91
    v_exp_f32 v92, v92
    v_exp_f32 v93, v93
    v_smfmac_f32_32x32x32_bf16 v[144:159], v[60:63], v[80:87], v112
    ds_read_b128 v[64:67], v131 offset:14560
    v_exp_f32 v94, v94
    v_exp_f32 v95, v95
    v_exp_f32 v96, v96
    v_exp_f32 v97, v97
    v_exp_f32 v98, v98
    v_smfmac_f32_32x32x32_bf16 v[160:175], v[56:59], v[88:95], v112
    ds_read_b128 v[68:71], v134 offset:14560
    v_exp_f32 v99, v99
    v_exp_f32 v100, v100
    v_exp_f32 v101, v101
    v_exp_f32 v102, v102
    v_exp_f32 v103, v103
    v_exp_f32 v208, v208
    v_mfma_f32_32x32x16_bf16 v[224:239], v[36:39], v[20:23], 0
    buffer_load_dwordx4 v4, s[44:47], s86 offen sc1 lds
    v_exp_f32 v209, v209
    v_exp_f32 v210, v210
    v_exp_f32 v211, v211
    v_exp_f32 v212, v212
    v_exp_f32 v213, v213
    v_smfmac_f32_32x32x32_bf16 v[160:175], v[60:63], v[96:103], v112
    s_waitcnt lgkmcnt(0)
    v_exp_f32 v214, v214
    v_exp_f32 v215, v215
    v_exp_f32 v216, v216
    v_exp_f32 v217, v217
    v_exp_f32 v218, v218
    v_smfmac_f32_32x32x32_bf16 v[144:159], v[64:67], v[208:215], v112
    buffer_load_dwordx4 v4, s[44:47], s86 offen offset:1024 sc1 lds
    v_exp_f32 v219, v219
    v_exp_f32 v220, v220
    v_exp_f32 v221, v221
    v_exp_f32 v222, v222
    v_exp_f32 v223, v223
    v_exp_f32 v224, v224
    v_mfma_f32_32x32x16_bf16 v[72:87], v[24:27], v[16:19], 0
    ds_read_b128 v[28:31], v128 offset:18720
    v_exp_f32 v225, v225
    v_exp_f32 v226, v226
    v_exp_f32 v227, v227
    v_exp_f32 v228, v228
    v_exp_f32 v229, v229
    v_smfmac_f32_32x32x32_bf16 v[144:159], v[68:71], v[216:223], v112
    ds_read_b128 v[40:43], v131 offset:16640
    v_exp_f32 v230, v230
    v_exp_f32 v231, v231
    v_exp_f32 v232, v232
    v_exp_f32 v233, v233
    v_exp_f32 v234, v234
    v_smfmac_f32_32x32x32_bf16 v[160:175], v[64:67], v[224:231], v112
    ds_read_b128 v[44:47], v134 offset:16640
    v_exp_f32 v235, v235
    v_exp_f32 v236, v236
    v_exp_f32 v237, v237
    v_exp_f32 v238, v238
    v_exp_f32 v239, v239
    v_exp_f32 v72, v72
    v_mfma_f32_32x32x16_bf16 v[88:103], v[24:27], v[20:23], 0
    s_waitcnt vmcnt(2)
    v_exp_f32 v73, v73
    v_exp_f32 v74, v74
    v_exp_f32 v75, v75
    v_exp_f32 v76, v76
    v_exp_f32 v77, v77
    v_smfmac_f32_32x32x32_bf16 v[160:175], v[68:71], v[232:239], v112
    s_waitcnt lgkmcnt(0)
    v_exp_f32 v78, v78
    v_exp_f32 v79, v79
    v_exp_f32 v80, v80
    v_exp_f32 v81, v81
    v_exp_f32 v82, v82
    v_smfmac_f32_32x32x32_bf16 v[144:159], v[40:43], v[72:79], v112
    ds_add_u32 v1, v2 offset:76
    v_exp_f32 v83, v83
    v_exp_f32 v84, v84
    v_exp_f32 v85, v85
    v_exp_f32 v86, v86
    v_exp_f32 v87, v87
    v_exp_f32 v88, v88
    v_mfma_f32_32x32x16_bf16 v[208:223], v[28:31], v[16:19], 0
    ds_read_b128 v[32:35], v128 offset:20800
    v_exp_f32 v89, v89
    v_exp_f32 v90, v90
    v_exp_f32 v91, v91
    v_exp_f32 v92, v92
    v_exp_f32 v93, v93
    v_smfmac_f32_32x32x32_bf16 v[144:159], v[44:47], v[80:87], v112
    ds_read_b128 v[48:51], v131 offset:18720
    v_exp_f32 v94, v94
    v_exp_f32 v95, v95
    v_exp_f32 v96, v96
    v_exp_f32 v97, v97
    v_exp_f32 v98, v98
    v_smfmac_f32_32x32x32_bf16 v[160:175], v[40:43], v[88:95], v112
    ds_read_b128 v[52:55], v134 offset:18720
    v_exp_f32 v99, v99
    v_exp_f32 v100, v100
    v_exp_f32 v101, v101
    v_exp_f32 v102, v102
    v_exp_f32 v103, v103
L_A_mid:
    v_exp_f32 v208, v208
    v_mfma_f32_32x32x16_bf16 v[224:239], v[28:31], v[20:23], 0
    s_mov_b32 m0, s9
    v_exp_f32 v209, v209
    v_exp_f32 v210, v210
    v_exp_f32 v211, v211
    v_exp_f32 v212, v212
    v_exp_f32 v213, v213
    v_smfmac_f32_32x32x32_bf16 v[160:175], v[44:47], v[96:103], v112
    s_waitcnt lgkmcnt(0)
    v_exp_f32 v214, v214
    v_exp_f32 v215, v215
    v_exp_f32 v216, v216
    v_exp_f32 v217, v217
    v_exp_f32 v218, v218
    v_smfmac_f32_32x32x32_bf16 v[144:159], v[48:51], v[208:215], v112
    ds_read_b32 v3, v1 offset:76
    v_exp_f32 v219, v219
    v_exp_f32 v220, v220
    v_exp_f32 v221, v221
    v_exp_f32 v222, v222
    v_exp_f32 v223, v223
    v_exp_f32 v224, v224
    v_mfma_f32_32x32x16_bf16 v[72:87], v[32:35], v[16:19], 0
    ds_read_b128 v[36:39], v128 offset:22880
    v_exp_f32 v225, v225
    v_exp_f32 v226, v226
    v_exp_f32 v227, v227
    v_exp_f32 v228, v228
    v_exp_f32 v229, v229
    v_smfmac_f32_32x32x32_bf16 v[144:159], v[52:55], v[216:223], v112
    ds_read_b128 v[56:59], v131 offset:20800
    v_exp_f32 v230, v230
    v_exp_f32 v231, v231
    v_exp_f32 v232, v232
    v_exp_f32 v233, v233
    v_exp_f32 v234, v234
    v_smfmac_f32_32x32x32_bf16 v[160:175], v[48:51], v[224:231], v112
    ds_read_b128 v[60:63], v134 offset:20800
    v_exp_f32 v235, v235
    v_exp_f32 v236, v236
    v_exp_f32 v237, v237
    v_exp_f32 v238, v238
    v_exp_f32 v239, v239
    v_exp_f32 v72, v72
    v_mfma_f32_32x32x16_bf16 v[88:103], v[32:35], v[20:23], 0
    s_add_u32 s86, s86, 8192
    s_and_b32 s86, s86, 0x1ffff
    v_exp_f32 v73, v73
    v_exp_f32 v74, v74
    v_exp_f32 v75, v75
    v_exp_f32 v76, v76
    v_exp_f32 v77, v77
    v_smfmac_f32_32x32x32_bf16 v[160:175], v[52:55], v[232:239], v112
    s_waitcnt lgkmcnt(0)
    v_exp_f32 v78, v78
    v_readfirstlane_b32 s84, v3
    v_exp_f32 v79, v79
    v_exp_f32 v80, v80
    v_exp_f32 v81, v81
    v_exp_f32 v82, v82
    v_smfmac_f32_32x32x32_bf16 v[144:159], v[56:59], v[72:79], v112
    s_cmp_ge_u32 s84, s85
    s_cbranch_scc0 L_spin_144
L_ok_143:
    v_exp_f32 v83, v83
    v_exp_f32 v84, v84
    v_exp_f32 v85, v85
    v_exp_f32 v86, v86
    v_exp_f32 v87, v87
    v_exp_f32 v88, v88
    v_mfma_f32_32x32x16_bf16 v[208:223], v[36:39], v[16:19], 0
    ds_read_b128 v[24:27], v129 offset:24704
    v_exp_f32 v89, v89
    v_exp_f32 v90, v90
    v_exp_f32 v91, v91
    v_exp_f32 v92, v92
    v_exp_f32 v93, v93
    v_smfmac_f32_32x32x32_bf16 v[144:159], v[60:63], v[80:87], v112
    ds_read_b128 v[64:67], v131 offset:22880
    v_exp_f32 v94, v94
    v_exp_f32 v95, v95
    v_exp_f32 v96, v96
    v_exp_f32 v97, v97
    v_exp_f32 v98, v98
    v_smfmac_f32_32x32x32_bf16 v[160:175], v[56:59], v[88:95], v112
    ds_read_b128 v[68:71], v134 offset:22880
    v_exp_f32 v99, v99
    v_exp_f32 v100, v100
    v_exp_f32 v101, v101
    v_exp_f32 v102, v102
    v_exp_f32 v103, v103
    v_exp_f32 v208, v208
    v_mfma_f32_32x32x16_bf16 v[224:239], v[36:39], v[20:23], 0
    buffer_load_dwordx4 v4, s[44:47], s86 offen sc1 lds
    v_exp_f32 v209, v209
    v_exp_f32 v210, v210
    v_exp_f32 v211, v211
    v_exp_f32 v212, v212
    v_exp_f32 v213, v213
    v_smfmac_f32_32x32x32_bf16 v[160:175], v[60:63], v[96:103], v112
    s_waitcnt lgkmcnt(0)
    v_exp_f32 v214, v214
    v_exp_f32 v215, v215
    v_exp_f32 v216, v216
    v_exp_f32 v217, v217
    v_exp_f32 v218, v218
    v_smfmac_f32_32x32x32_bf16 v[144:159], v[64:67], v[208:215], v112
    buffer_load_dwordx4 v4, s[44:47], s86 offen offset:1024 sc1 lds
    v_exp_f32 v219, v219
    v_exp_f32 v220, v220
    v_exp_f32 v221, v221
    v_exp_f32 v222, v222
    v_exp_f32 v223, v223
    v_exp_f32 v224, v224
    v_mfma_f32_32x32x16_bf16 v[72:87], v[24:27], v[16:19], 0
    ds_read_b128 v[28:31], v129 offset:57472
    v_exp_f32 v225, v225
    v_exp_f32 v226, v226
    v_exp_f32 v227, v227
    v_exp_f32 v228, v228
    v_exp_f32 v229, v229
    v_smfmac_f32_32x32x32_bf16 v[144:159], v[68:71], v[216:223], v112
    ds_read_b128 v[40:43], v132 offset:24704
    v_exp_f32 v230, v230
    v_exp_f32 v231, v231
    v_exp_f32 v232, v232
    v_exp_f32 v233, v233
    v_exp_f32 v234, v234
    v_smfmac_f32_32x32x32_bf16 v[160:175], v[64:67], v[224:231], v112
    ds_read_b128 v[44:47], v135 offset:24704
    v_exp_f32 v235, v235
    v_exp_f32 v236, v236
    v_exp_f32 v237, v237
    v_exp_f32 v238, v238
    v_exp_f32 v239, v239
    v_exp_f32 v72, v72
    v_mfma_f32_32x32x16_bf16 v[88:103], v[24:27], v[20:23], 0
    s_waitcnt vmcnt(2)
    v_exp_f32 v73, v73
    v_exp_f32 v74, v74
    v_exp_f32 v75, v75
    v_exp_f32 v76, v76
    v_exp_f32 v77, v77
    v_smfmac_f32_32x32x32_bf16 v[160:175], v[68:71], v[232:239], v112
    s_waitcnt lgkmcnt(0)
    v_exp_f32 v78, v78
    v_exp_f32 v79, v79
    v_exp_f32 v80, v80
    v_exp_f32 v81, v81
    v_exp_f32 v82, v82
    v_smfmac_f32_32x32x32_bf16 v[144:159], v[40:43], v[72:79], v112
    ds_add_u32 v1, v2 offset:64
    v_exp_f32 v83, v83
    v_exp_f32 v84, v84
    v_exp_f32 v85, v85
    v_exp_f32 v86, v86
    v_exp_f32 v87, v87
    v_exp_f32 v88, v88
    v_mfma_f32_32x32x16_bf16 v[208:223], v[28:31], v[16:19], 0
    ds_read_b128 v[32:35], v130 offset:24704
    v_exp_f32 v89, v89
    v_exp_f32 v90, v90
    v_exp_f32 v91, v91
    v_exp_f32 v92, v92
    v_exp_f32 v93, v93
    v_smfmac_f32_32x32x32_bf16 v[144:159], v[44:47], v[80:87], v112
    ds_read_b128 v[48:51], v132 offset:57472
    v_exp_f32 v94, v94
    v_exp_f32 v95, v95
    v_exp_f32 v96, v96
    v_exp_f32 v97, v97
    v_exp_f32 v98, v98
    v_smfmac_f32_32x32x32_bf16 v[160:175], v[40:43], v[88:95], v112
    ds_read_b128 v[52:55], v135 offset:57472
    v_exp_f32 v99, v99
    v_exp_f32 v100, v100
    v_exp_f32 v101, v101
    v_exp_f32 v102, v102
    v_exp_f32 v103, v103
    v_exp_f32 v208, v208
    v_mfma_f32_32x32x16_bf16 v[224:239], v[28:31], v[20:23], 0
    s_mov_b32 m0, s10
    s_add_u32 s85, s85, 4
    v_exp_f32 v209, v209
    v_exp_f32 v210, v210
    v_exp_f32 v211, v211
    v_exp_f32 v212, v212
    v_exp_f32 v213, v213
    v_smfmac_f32_32x32x32_bf16 v[160:175], v[44:47], v[96:103], v112
    s_waitcnt lgkmcnt(0)
    s_cmp_eq_u32 s87, 2
    s_cselect_b32 s14, 40960, s14
    v_exp_f32 v214, v214
    v_exp_f32 v215, v215
    v_exp_f32 v216, v216
    v_exp_f32 v217, v217
    v_exp_f32 v218, v218
    v_smfmac_f32_32x32x32_bf16 v[144:159], v[48:51], v[208:215], v112
    ds_read_b32 v3, v1 offset:64
    v_exp_f32 v219, v219
    v_exp_f32 v220, v220
    v_exp_f32 v221, v221
    v_exp_f32 v222, v222
    v_exp_f32 v223, v223
    v_exp_f32 v224, v224
    v_mfma_f32_32x32x16_bf16 v[72:87], v[32:35], v[16:19], 0
    ds_read_b128 v[36:39], v130 offset:57472
    v_exp_f32 v225, v225
    v_exp_f32 v226, v226
    v_exp_f32 v227, v227
    v_exp_f32 v228, v228
    v_exp_f32 v229, v229
    v_smfmac_f32_32x32x32_bf16 v[144:159], v[52:55], v[216:223], v112
    ds_read_b128 v[56:59], v133 offset:24704
    v_exp_f32 v230, v230
    v_exp_f32 v231, v231
    v_exp_f32 v232, v232
    v_exp_f32 v233, v233
    v_exp_f32 v234, v234
    v_smfmac_f32_32x32x32_bf16 v[160:175], v[48:51], v[224:231], v112
    ds_read_b128 v[60:63], v136 offset:24704
    v_exp_f32 v235, v235
    v_exp_f32 v236, v236
    v_exp_f32 v237, v237
    v_exp_f32 v238, v238
    v_exp_f32 v239, v239
    v_exp_f32 v72, v72
    v_mfma_f32_32x32x16_bf16 v[88:103], v[32:35], v[20:23], 0
    s_add_u32 s86, s86, 8192
    s_and_b32 s86, s86, 0x1ffff
    v_exp_f32 v73, v73
    v_exp_f32 v74, v74
    v_exp_f32 v75, v75
    v_exp_f32 v76, v76
    v_exp_f32 v77, v77
    v_smfmac_f32_32x32x32_bf16 v[160:175], v[52:55], v[232:239], v112
    s_waitcnt lgkmcnt(0)
    v_exp_f32 v78, v78
    v_readfirstlane_b32 s84, v3
    v_exp_f32 v79, v79
    v_exp_f32 v80, v80
    v_exp_f32 v81, v81
    v_exp_f32 v82, v82
    v_smfmac_f32_32x32x32_bf16 v[144:159], v[56:59], v[72:79], v112
    s_cmp_ge_u32 s84, s85
    s_cbranch_scc0 L_spin_146
L_ok_145:
    v_exp_f32 v83, v83
    v_exp_f32 v84, v84
    v_exp_f32 v85, v85
    v_exp_f32 v86, v86
    v_exp_f32 v87, v87
    v_exp_f32 v88, v88
    v_mfma_f32_32x32x16_bf16 v[208:223], v[36:39], v[16:19], 0
    ds_read_b128 v[24:27], v128 offset:0
    v_exp_f32 v89, v89
    v_exp_f32 v90, v90
    v_exp_f32 v91, v91
    v_exp_f32 v92, v92
    v_exp_f32 v93, v93
    v_smfmac_f32_32x32x32_bf16 v[144:159], v[60:63], v[80:87], v112
    ds_read_b128 v[64:67], v133 offset:57472
    v_exp_f32 v94, v94
    v_exp_f32 v95, v95
    v_exp_f32 v96, v96
    v_exp_f32 v97, v97
    v_exp_f32 v98, v98
    v_smfmac_f32_32x32x32_bf16 v[160:175], v[56:59], v[88:95], v112
    ds_read_b128 v[68:71], v136 offset:57472
    s_cmp_eq_u32 s87, 1
    v_exp_f32 v99, v99
    v_exp_f32 v100, v100
    v_exp_f32 v101, v101
    v_exp_f32 v102, v102
    v_exp_f32 v103, v103
    s_cbranch_scc1 L_A_last
    v_exp_f32 v208, v208
    v_mfma_f32_32x32x16_bf16 v[224:239], v[36:39], v[20:23], 0
    buffer_load_dwordx4 v4, s[44:47], s86 offen sc1 lds
    v_exp_f32 v209, v209
    v_exp_f32 v210, v210
    v_exp_f32 v211, v211
    v_exp_f32 v212, v212
    v_exp_f32 v213, v213
    v_smfmac_f32_32x32x32_bf16 v[160:175], v[60:63], v[96:103], v112
    s_waitcnt lgkmcnt(0)
    v_exp_f32 v214, v214
    v_exp_f32 v215, v215
    v_exp_f32 v216, v216
    v_exp_f32 v217, v217
    v_exp_f32 v218, v218
    v_smfmac_f32_32x32x32_bf16 v[144:159], v[64:67], v[208:215], v112
    buffer_load_dwordx4 v4, s[44:47], s86 offen offset:1024 sc1 lds
    v_exp_f32 v219, v219
    v_exp_f32 v220, v220
    v_exp_f32 v221, v221
    v_exp_f32 v222, v222
    v_exp_f32 v223, v223
    v_exp_f32 v224, v224
    v_mfma_f32_32x32x16_bf16 v[72:87], v[24:27], v[16:19], 0
    ds_read_b128 v[28:31], v128 offset:2080
    v_exp_f32 v225, v225
    v_exp_f32 v226, v226
    v_exp_f32 v227, v227
    v_exp_f32 v228, v228
    v_exp_f32 v229, v229
    v_smfmac_f32_32x32x32_bf16 v[144:159], v[68:71], v[216:223], v112
    ds_read_b128 v[40:43], v131 offset:0
    s_sub_u32 s87, s87, 1
    v_exp_f32 v230, v230
    v_exp_f32 v231, v231
    v_exp_f32 v232, v232
    v_exp_f32 v233, v233
    v_exp_f32 v234, v234
    v_smfmac_f32_32x32x32_bf16 v[160:175], v[64:67], v[224:231], v112
    ds_read_b128 v[44:47], v134 offset:0
    s_cmp_lg_u32 s87, 3
    v_exp_f32 v235, v235
    v_exp_f32 v236, v236
    v_exp_f32 v237, v237
    v_exp_f32 v238, v238
    v_exp_f32 v239, v239
    s_cbranch_scc1 L_A_loop
    s_waitcnt lgkmcnt(2)
    s_waitcnt vmcnt(2)
    v_exp_f32 v72, v72
    v_mfma_f32_32x32x16_bf16 v[88:103], v[28:31], v[16:19], 0
    ds_read_b128 v[32:35], v128 offset:4160
    ds_add_u32 v1, v2 offset:68
    v_exp_f32 v73, v73
    v_exp_f32 v74, v74
    v_exp_f32 v75, v75
    v_exp_f32 v76, v76
    v_exp_f32 v77, v77
    v_smfmac_f32_32x32x32_bf16 v[160:175], v[68:71], v[232:239], v112
    s_waitcnt lgkmcnt(2)
    ds_read_b128 v[48:51], v131 offset:2080
    v_exp_f32 v78, v78
    v_exp_f32 v79, v79
    v_exp_f32 v80, v80
    v_exp_f32 v81, v81
    v_exp_f32 v82, v82
    v_smfmac_f32_32x32x32_bf16 v[144:159], v[40:43], v[72:79], v112
    ds_read_b128 v[52:55], v134 offset:2080
    s_add_u32 s86, s86, 8192
    s_and_b32 s86, s86, 0x1ffff
    s_mov_b32 m0, s11
    v_exp_f32 v83, v83
    v_exp_f32 v84, v84
    v_exp_f32 v85, v85
    v_exp_f32 v86, v86
    v_exp_f32 v87, v87
    s_waitcnt lgkmcnt(3)
    v_exp_f32 v88, v88
    v_mfma_f32_32x32x16_bf16 v[208:223], v[32:35], v[16:19], 0
    ds_read_b32 v3, v1 offset:68
    ds_read_b128 v[36:39], v128 offset:6240
    v_exp_f32 v89, v89
    v_exp_f32 v90, v90
    v_exp_f32 v91, v91
    v_exp_f32 v92, v92
    v_exp_f32 v93, v93
    v_smfmac_f32_32x32x32_bf16 v[144:159], v[44:47], v[80:87], v112
    ds_read_b128 v[56:59], v131 offset:4160
    buffer_load_dword v137, v14, s[72:75], s23 offen sc1
    v_exp_f32 v94, v94
    v_exp_f32 v95, v95
    v_exp_f32 v96, v96
    v_exp_f32 v97, v97
    s_waitcnt lgkmcnt(3)
    v_exp_f32 v98, v98
    v_smfmac_f32_32x32x32_bf16 v[144:159], v[48:51], v[88:95], v112
    ds_read_b128 v[60:63], v134 offset:4160
    v_exp_f32 v99, v99
    s_waitcnt lgkmcnt(3)
    v_readfirstlane_b32 s84, v3
    v_exp_f32 v100, v100
    v_exp_f32 v101, v101
    v_exp_f32 v102, v102
    v_exp_f32 v103, v103
    s_waitcnt lgkmcnt(2)
    s_cmp_ge_u32 s84, s85
    s_cbranch_scc0 L_spin_148
L_ok_147:
    v_exp_f32 v208, v208
    v_mfma_f32_32x32x16_bf16 v[224:239], v[36:39], v[16:19], 0
    ds_read_b128 v[24:27], v128 offset:8320
    v_exp_f32 v209, v209
    v_exp_f32 v210, v210
    v_exp_f32 v211, v211
    v_exp_f32 v212, v212
    v_exp_f32 v213, v213
    v_smfmac_f32_32x32x32_bf16 v[144:159], v[52:55], v[96:103], v112
    s_waitcnt lgkmcnt(1)
    ds_read_b128 v[64:67], v131 offset:6240
    v_exp_f32 v214, v214
    v_exp_f32 v215, v215
    v_exp_f32 v216, v216
    v_exp_f32 v217, v217
    v_exp_f32 v218, v218
    v_smfmac_f32_32x32x32_bf16 v[144:159], v[56:59], v[208:215], v112
    ds_read_b128 v[68:71], v134 offset:6240
    v_exp_f32 v219, v219
    v_exp_f32 v220, v220
    v_exp_f32 v221, v221
    v_exp_f32 v222, v222
    v_exp_f32 v223, v223
    s_waitcnt lgkmcnt(2)
    v_exp_f32 v224, v224
    v_mfma_f32_32x32x16_bf16 v[72:87], v[24:27], v[16:19], 0
    ds_read_b128 v[28:31], v128 offset:10400
    buffer_load_dwordx4 v4, s[44:47], s86 offen sc1 lds
    buffer_load_dwordx4 v4, s[44:47], s86 offen offset:1024 sc1 lds
    v_exp_f32 v225, v225
    v_exp_f32 v226, v226
    v_exp_f32 v227, v227
    v_exp_f32 v228, v228
    v_exp_f32 v229, v229
    v_smfmac_f32_32x32x32_bf16 v[144:159], v[60:63], v[216:223], v112
    ds_read_b128 v[40:43], v131 offset:8320
    v_exp_f32 v230, v230
    v_exp_f32 v231, v231
    v_exp_f32 v232, v232
    v_exp_f32 v233, v233
    s_waitcnt lgkmcnt(2)
    v_exp_f32 v234, v234
    v_smfmac_f32_32x32x32_bf16 v[144:159], v[64:67], v[224:231], v112
    ds_read_b128 v[44:47], v134 offset:8320
    v_exp_f32 v235, v235
    v_exp_f32 v236, v236
    v_exp_f32 v237, v237
    v_exp_f32 v238, v238
    v_exp_f32 v239, v239
    s_waitcnt lgkmcnt(2)
    s_waitcnt vmcnt(2)
    v_exp_f32 v72, v72
    v_mfma_f32_32x32x16_bf16 v[88:103], v[28:31], v[16:19], 0
    ds_read_b128 v[32:35], v128 offset:12480
    ds_add_u32 v1, v2 offset:72
    v_exp_f32 v73, v73
    v_exp_f32 v74, v74
    v_exp_f32 v75, v75
    v_exp_f32 v76, v76
    v_exp_f32 v77, v77
    v_smfmac_f32_32x32x32_bf16 v[144:159], v[68:71], v[232:239], v112
    s_waitcnt lgkmcnt(2)
    ds_read_b128 v[48:51], v131 offset:10400
    v_exp_f32 v78, v78
    v_exp_f32 v79, v79
    v_exp_f32 v80, v80
    v_exp_f32 v81, v81
    v_exp_f32 v82, v82
    v_smfmac_f32_32x32x32_bf16 v[144:159], v[40:43], v[72:79], v112
    ds_read_b128 v[52:55], v134 offset:10400
    s_add_u32 s86, s86, 8192
    s_and_b32 s86, s86, 0x1ffff
    s_mov_b32 m0, s8
    v_exp_f32 v83, v83
    v_exp_f32 v84, v84
    v_exp_f32 v85, v85
    v_exp_f32 v86, v86
    v_exp_f32 v87, v87
    s_waitcnt lgkmcnt(3)
    v_exp_f32 v88, v88
    v_mfma_f32_32x32x16_bf16 v[208:223], v[32:35], v[16:19], 0
    ds_read_b32 v3, v1 offset:72
    ds_read_b128 v[36:39], v128 offset:14560
    v_exp_f32 v89, v89
    v_exp_f32 v90, v90
    v_exp_f32 v91, v91
    v_exp_f32 v92, v92
    v_exp_f32 v93, v93
    v_smfmac_f32_32x32x32_bf16 v[144:159], v[44:47], v[80:87], v112
    ds_read_b128 v[56:59], v131 offset:12480
    v_exp_f32 v94, v94
    v_exp_f32 v95, v95
    v_exp_f32 v96, v96
    v_exp_f32 v97, v97
    s_waitcnt lgkmcnt(3)
    v_exp_f32 v98, v98
    v_smfmac_f32_32x32x32_bf16 v[144:159], v[48:51], v[88:95], v112
    ds_read_b128 v[60:63], v134 offset:12480
    v_exp_f32 v99, v99
    s_waitcnt lgkmcnt(3)
    v_readfirstlane_b32 s84, v3
    v_exp_f32 v100, v100
    v_exp_f32 v101, v101
    v_exp_f32 v102, v102
    v_exp_f32 v103, v103
    s_waitcnt lgkmcnt(2)
    s_cmp_ge_u32 s84, s85
    s_cbranch_scc0 L_spin_150
L_ok_149:
    v_exp_f32 v208, v208
    v_mfma_f32_32x32x16_bf16 v[224:239], v[36:39], v[16:19], 0
    ds_read_b128 v[24:27], v128 offset:16640
    v_exp_f32 v209, v209
    v_exp_f32 v210, v210
    v_exp_f32 v211, v211
    v_mul_f32 v137, 0xbfb8aa3b, v137
    v_exp_f32 v212, v212
    v_exp_f32 v213, v213
    v_smfmac_f32_32x32x32_bf16 v[144:159], v[52:55], v[96:103], v112
    s_waitcnt lgkmcnt(1)
    ds_read_b128 v[64:67], v131 offset:14560
    v_exp_f32 v214, v214
    v_exp_f32 v215, v215
    v_exp_f32 v216, v216
    v_exp_f32 v137, v137
    v_exp_f32 v217, v217
    v_exp_f32 v218, v218
    v_smfmac_f32_32x32x32_bf16 v[144:159], v[56:59], v[208:215], v112
    ds_read_b128 v[68:71], v134 offset:14560
    v_exp_f32 v219, v219
    v_exp_f32 v220, v220
    v_exp_f32 v221, v221
    v_add_f32 v137, 1.0, v137
    v_exp_f32 v222, v222
    v_exp_f32 v223, v223
    s_waitcnt lgkmcnt(2)
    v_exp_f32 v224, v224
    v_mfma_f32_32x32x16_bf16 v[72:87], v[24:27], v[16:19], 0
    ds_read_b128 v[28:31], v128 offset:18720
    buffer_load_dwordx4 v4, s[44:47], s86 offen sc1 lds
    buffer_load_dwordx4 v4, s[44:47], s86 offen offset:1024 sc1 lds
    v_exp_f32 v225, v225
    v_exp_f32 v226, v226
    v_exp_f32 v227, v227
    v_rcp_f32 v137, v137
    v_exp_f32 v228, v228
    v_exp_f32 v229, v229
    v_smfmac_f32_32x32x32_bf16 v[144:159], v[60:63], v[216:223], v112
    ds_read_b128 v[40:43], v131 offset:16640
    v_exp_f32 v230, v230
    v_exp_f32 v231, v231
    v_exp_f32 v232, v232
    v_exp_f32 v233, v233
    s_waitcnt lgkmcnt(2)
    v_exp_f32 v234, v234
    v_smfmac_f32_32x32x32_bf16 v[144:159], v[64:67], v[224:231], v112
    ds_read_b128 v[44:47], v134 offset:16640
    v_exp_f32 v235, v235
    v_exp_f32 v236, v236
    v_exp_f32 v237, v237
    v_exp_f32 v238, v238
    v_exp_f32 v239, v239
    v_exp_f32 v72, v72
    v_mfma_f32_32x32x16_bf16 v[88:103], v[24:27], v[20:23], 0
    s_waitcnt vmcnt(2)
    v_exp_f32 v73, v73
    v_exp_f32 v74, v74
    v_exp_f32 v75, v75
    v_exp_f32 v76, v76
    v_exp_f32 v77, v77
    v_smfmac_f32_32x32x32_bf16 v[144:159], v[68:71], v[232:239], v112
    s_waitcnt lgkmcnt(0)
    v_exp_f32 v78, v78
    v_exp_f32 v79, v79
    v_exp_f32 v80, v80
    v_exp_f32 v81, v81
    v_exp_f32 v82, v82
    v_smfmac_f32_32x32x32_bf16 v[144:159], v[40:43], v[72:79], v112
    ds_add_u32 v1, v2 offset:76
    v_exp_f32 v83, v83
    v_exp_f32 v84, v84
    v_exp_f32 v85, v85
    v_exp_f32 v86, v86
    v_exp_f32 v87, v87
    v_exp_f32 v88, v88
    v_mfma_f32_32x32x16_bf16 v[208:223], v[28:31], v[16:19], 0
    ds_read_b128 v[32:35], v128 offset:20800
    v_exp_f32 v89, v89
    v_exp_f32 v90, v90
    v_exp_f32 v91, v91
    v_exp_f32 v92, v92
    v_exp_f32 v93, v93
    v_smfmac_f32_32x32x32_bf16 v[144:159], v[44:47], v[80:87], v112
    ds_read_b128 v[48:51], v131 offset:18720
    v_exp_f32 v94, v94
    v_exp_f32 v95, v95
    v_exp_f32 v96, v96
    v_exp_f32 v97, v97
    v_exp_f32 v98, v98
    v_smfmac_f32_32x32x32_bf16 v[160:175], v[40:43], v[88:95], v112
    ds_read_b128 v[52:55], v134 offset:18720
    v_exp_f32 v99, v99
    v_exp_f32 v100, v100
    v_exp_f32 v101, v101
    v_exp_f32 v102, v102
    v_exp_f32 v103, v103
    s_branch L_A_mid
L_A_last:
    v_exp_f32 v208, v208
    v_mfma_f32_32x32x16_bf16 v[224:239], v[36:39], v[20:23], 0
    v_exp_f32 v209, v209
    v_exp_f32 v210, v210
    v_exp_f32 v211, v211
    v_exp_f32 v212, v212
    v_exp_f32 v213, v213
    v_smfmac_f32_32x32x32_bf16 v[160:175], v[60:63], v[96:103], v112
    s_waitcnt vmcnt(0) lgkmcnt(0)
    v_exp_f32 v214, v214
    v_exp_f32 v215, v215
    v_exp_f32 v216, v216
    v_exp_f32 v217, v217
    v_exp_f32 v218, v218
    v_smfmac_f32_32x32x32_bf16 v[144:159], v[64:67], v[208:215], v112
    v_exp_f32 v219, v219
    v_exp_f32 v220, v220
    v_exp_f32 v221, v221
    v_exp_f32 v222, v222
    v_exp_f32 v223, v223
    v_exp_f32 v224, v224
    v_mfma_f32_32x32x16_bf16 v[72:87], v[24:27], v[20:23], 0
    ds_read_b128 v[28:31], v128 offset:2080
    v_exp_f32 v225, v225
    v_exp_f32 v226, v226
    v_exp_f32 v227, v227
    v_exp_f32 v228, v228
    v_exp_f32 v229, v229
    v_smfmac_f32_32x32x32_bf16 v[144:159], v[68:71], v[216:223], v112
    ds_read_b128 v[40:43], v131 offset:0
    v_exp_f32 v230, v230
    v_exp_f32 v231, v231
    v_exp_f32 v232, v232
    v_exp_f32 v233, v233
    v_exp_f32 v234, v234
    v_smfmac_f32_32x32x32_bf16 v[160:175], v[64:67], v[224:231], v112
    ds_read_b128 v[44:47], v134 offset:0
    v_exp_f32 v235, v235
    v_exp_f32 v236, v236
    v_exp_f32 v237, v237
    v_exp_f32 v238, v238
    v_exp_f32 v239, v239
    s_waitcnt lgkmcnt(2)
    v_exp_f32 v72, v72
    v_mfma_f32_32x32x16_bf16 v[88:103], v[28:31], v[20:23], 0
    ds_read_b128 v[32:35], v128 offset:4160
    ds_add_u32 v1, v2 offset:68
    v_exp_f32 v73, v73
    v_exp_f32 v74, v74
    v_pk_add_f32 v[120:121], v[144:145], v[146:147]
    v_pk_add_f32 v[122:123], v[148:149], v[150:151]
    v_pk_add_f32 v[120:121], v[120:121], v[122:123]
    v_add_f32 v120, v120, v121
    v_fma_f32 v120, v120, 0, v152
    v_subrev_u32 v120, s16, v120
    v_cmp_le_u32 vcc, s17, v120
    v_rcp_f32 v122, v152
    s_nop 0
    v_mul_f32 v122, v122, v137
    s_cbranch_vccnz L_A_abad
    v_pk_mul_f32 v[144:145], v[144:145], v[122:123] op_sel_hi:[1,0]
    v_pk_mul_f32 v[146:147], v[146:147], v[122:123] op_sel_hi:[1,0]
    v_pk_mul_f32 v[148:149], v[148:149], v[122:123] op_sel_hi:[1,0]
    v_pk_mul_f32 v[150:151], v[150:151], v[122:123] op_sel_hi:[1,0]
    v_cvt_pk_bf16_f32 v124, v144, v145
    v_cvt_pk_bf16_f32 v125, v146, v147
    v_cvt_pk_bf16_f32 v126, v148, v149
    v_cvt_pk_bf16_f32 v127, v150, v151
    v_min_u32 v124, -2, v124
    v_min_u32 v125, -2, v125
    v_min_u32 v126, -2, v126
    v_min_u32 v127, -2, v127
    buffer_store_dwordx4 v[124:127], v4, s[72:75], s19 offen sc1
L_A_aback:
    ds_add_u32 v1, v2 offset:96
    v_exp_f32 v75, v75
    v_exp_f32 v76, v76
    v_exp_f32 v77, v77
    v_smfmac_f32_32x32x32_bf16 v[160:175], v[68:71], v[232:239], v112
    s_waitcnt lgkmcnt(3)
    ds_read_b128 v[48:51], v131 offset:2080
    v_exp_f32 v78, v78
    v_exp_f32 v79, v79
    v_exp_f32 v80, v80
    v_exp_f32 v81, v81
    v_exp_f32 v82, v82
    v_smfmac_f32_32x32x32_bf16 v[160:175], v[40:43], v[72:79], v112
    ds_read_b128 v[52:55], v134 offset:2080
    v_exp_f32 v83, v83
    v_exp_f32 v84, v84
    v_exp_f32 v85, v85
    v_exp_f32 v86, v86
    v_exp_f32 v87, v87
    s_waitcnt lgkmcnt(4)
    v_exp_f32 v88, v88
    v_mfma_f32_32x32x16_bf16 v[208:223], v[32:35], v[20:23], 0
    ds_read_b32 v3, v1 offset:68
    ds_read_b128 v[36:39], v128 offset:6240
    v_exp_f32 v89, v89
    v_exp_f32 v90, v90
    v_exp_f32 v91, v91
    v_exp_f32 v92, v92
    v_exp_f32 v93, v93
    v_smfmac_f32_32x32x32_bf16 v[160:175], v[44:47], v[80:87], v112
    ds_read_b128 v[56:59], v131 offset:4160
    v_exp_f32 v94, v94
    v_exp_f32 v95, v95
    v_exp_f32 v96, v96
    v_exp_f32 v97, v97
    s_waitcnt lgkmcnt(3)
    v_exp_f32 v98, v98
    v_smfmac_f32_32x32x32_bf16 v[160:175], v[48:51], v[88:95], v112
    ds_read_b128 v[60:63], v134 offset:4160
    v_exp_f32 v99, v99
    s_waitcnt lgkmcnt(3)
    v_readfirstlane_b32 s84, v3
    v_exp_f32 v100, v100
    v_exp_f32 v101, v101
    v_exp_f32 v102, v102
    v_exp_f32 v103, v103
    s_waitcnt lgkmcnt(2)
    s_cmp_ge_u32 s84, s85
    s_cbranch_scc0 L_spin_152
L_ok_151:
    v_exp_f32 v208, v208
    v_mfma_f32_32x32x16_bf16 v[224:239], v[36:39], v[20:23], 0
    ds_read_b128 v[24:27], v128 offset:8320
    v_exp_f32 v209, v209
    v_exp_f32 v210, v210
    v_exp_f32 v211, v211
    v_exp_f32 v212, v212
    v_exp_f32 v213, v213
    v_smfmac_f32_32x32x32_bf16 v[160:175], v[52:55], v[96:103], v112
    s_waitcnt lgkmcnt(1)
    ds_read_b128 v[64:67], v131 offset:6240
    v_exp_f32 v214, v214
    v_exp_f32 v215, v215
    v_exp_f32 v216, v216
    v_exp_f32 v217, v217
    v_exp_f32 v218, v218
    v_smfmac_f32_32x32x32_bf16 v[160:175], v[56:59], v[208:215], v112
    ds_read_b128 v[68:71], v134 offset:6240
    v_exp_f32 v219, v219
    v_exp_f32 v220, v220
    v_exp_f32 v221, v221
    v_exp_f32 v222, v222
    v_exp_f32 v223, v223
    s_waitcnt lgkmcnt(2)
    v_exp_f32 v224, v224
    v_mfma_f32_32x32x16_bf16 v[72:87], v[24:27], v[20:23], 0
    ds_read_b128 v[28:31], v128 offset:10400
    v_exp_f32 v225, v225
    v_exp_f32 v226, v226
    v_exp_f32 v227, v227
    v_exp_f32 v228, v228
    v_exp_f32 v229, v229
    v_smfmac_f32_32x32x32_bf16 v[160:175], v[60:63], v[216:223], v112
    ds_read_b128 v[40:43], v131 offset:8320
    v_exp_f32 v230, v230
    v_exp_f32 v231, v231
    v_exp_f32 v232, v232
    v_exp_f32 v233, v233
    s_waitcnt lgkmcnt(2)
    v_exp_f32 v234, v234
    v_smfmac_f32_32x32x32_bf16 v[160:175], v[64:67], v[224:231], v112
    ds_read_b128 v[44:47], v134 offset:8320
    v_exp_f32 v235, v235
    v_exp_f32 v236, v236
    v_exp_f32 v237, v237
    v_exp_f32 v238, v238
    v_exp_f32 v239, v239
    s_waitcnt lgkmcnt(2)
    v_exp_f32 v72, v72
    v_mfma_f32_32x32x16_bf16 v[88:103], v[28:31], v[20:23], 0
    ds_read_b128 v[32:35], v128 offset:12480
    v_exp_f32 v73, v73
    v_exp_f32 v74, v74
    v_exp_f32 v75, v75
    v_exp_f32 v76, v76
    v_exp_f32 v77, v77
    v_smfmac_f32_32x32x32_bf16 v[160:175], v[68:71], v[232:239], v112
    s_waitcnt lgkmcnt(1)
    ds_read_b128 v[48:51], v131 offset:10400
    v_exp_f32 v78, v78
    v_exp_f32 v79, v79
    v_exp_f32 v80, v80
    v_exp_f32 v81, v81
    v_exp_f32 v82, v82
    v_smfmac_f32_32x32x32_bf16 v[160:175], v[40:43], v[72:79], v112
    ds_read_b128 v[52:55], v134 offset:10400
    v_exp_f32 v83, v83
    v_exp_f32 v84, v84
    v_exp_f32 v85, v85
    v_exp_f32 v86, v86
    v_exp_f32 v87, v87
    s_waitcnt lgkmcnt(2)
    v_exp_f32 v88, v88
    v_mfma_f32_32x32x16_bf16 v[208:223], v[32:35], v[20:23], 0
    ds_read_b128 v[36:39], v128 offset:14560
    v_exp_f32 v89, v89
    v_exp_f32 v90, v90
    v_exp_f32 v91, v91
    v_exp_f32 v92, v92
    v_exp_f32 v93, v93
    v_smfmac_f32_32x32x32_bf16 v[160:175], v[44:47], v[80:87], v112
    ds_read_b128 v[56:59], v131 offset:12480
    v_exp_f32 v94, v94
    v_exp_f32 v95, v95
    v_exp_f32 v96, v96
    v_exp_f32 v97, v97
    s_waitcnt lgkmcnt(2)
    v_exp_f32 v98, v98
    v_smfmac_f32_32x32x32_bf16 v[160:175], v[48:51], v[88:95], v112
    ds_read_b128 v[60:63], v134 offset:12480
    v_exp_f32 v99, v99
    v_exp_f32 v100, v100
    v_exp_f32 v101, v101
    v_exp_f32 v102, v102
    v_exp_f32 v103, v103
    s_waitcnt lgkmcnt(2)
    v_exp_f32 v208, v208
    v_mfma_f32_32x32x16_bf16 v[224:239], v[36:39], v[20:23], 0
    v_exp_f32 v209, v209
    v_exp_f32 v210, v210
    v_exp_f32 v211, v211
    v_exp_f32 v212, v212
    v_exp_f32 v213, v213
    v_smfmac_f32_32x32x32_bf16 v[160:175], v[52:55], v[96:103], v112
    s_waitcnt lgkmcnt(0)
    ds_read_b128 v[64:67], v131 offset:14560
    v_exp_f32 v214, v214
    v_exp_f32 v215, v215
    v_exp_f32 v216, v216
    v_exp_f32 v217, v217
    v_exp_f32 v218, v218
    v_smfmac_f32_32x32x32_bf16 v[160:175], v[56:59], v[208:215], v112
    ds_read_b128 v[68:71], v134 offset:14560
    v_exp_f32 v219, v219
    v_exp_f32 v220, v220
    v_exp_f32 v221, v221
    v_exp_f32 v222, v222
    v_exp_f32 v223, v223
    v_exp_f32 v224, v224
    v_exp_f32 v225, v225
    v_exp_f32 v226, v226
    v_exp_f32 v227, v227
    v_exp_f32 v228, v228
    v_exp_f32 v229, v229
    v_smfmac_f32_32x32x32_bf16 v[160:175], v[60:63], v[216:223], v112
    v_exp_f32 v230, v230
    v_exp_f32 v231, v231
    v_exp_f32 v232, v232
    v_exp_f32 v233, v233
    s_waitcnt lgkmcnt(0)
    v_exp_f32 v234, v234
    v_smfmac_f32_32x32x32_bf16 v[160:175], v[64:67], v[224:231], v112
    v_exp_f32 v235, v235
    v_exp_f32 v236, v236
    v_exp_f32 v237, v237
    v_exp_f32 v238, v238
    v_exp_f32 v239, v239
    s_nop 1
    v_smfmac_f32_32x32x32_bf16 v[160:175], v[68:71], v[232:239], v112
    s_cmp_lg_u32 s15, 0
    s_cbranch_scc1 L_A_slow
    s_nop 9
    v_pk_add_f32 v[120:121], v[160:161], v[162:163]
    v_pk_add_f32 v[122:123], v[164:165], v[166:167]
    v_pk_add_f32 v[120:121], v[120:121], v[122:123]
    v_add_f32 v120, v120, v121
    v_fma_f32 v120, v120, 0, v168
    v_subrev_u32 v120, s16, v120
    v_cmp_le_u32 vcc, s17, v120
    v_rcp_f32 v122, v168
    s_nop 0
    v_mul_f32 v122, v122, v137
    s_cbranch_vccnz L_A_slow
L_A_fin:
    v_pk_mul_f32 v[160:161], v[160:161], v[122:123] op_sel_hi:[1,0]
    v_pk_mul_f32 v[162:163], v[162:163], v[122:123] op_sel_hi:[1,0]
    v_pk_mul_f32 v[164:165], v[164:165], v[122:123] op_sel_hi:[1,0]
    v_pk_mul_f32 v[166:167], v[166:167], v[122:123] op_sel_hi:[1,0]
    v_cvt_pk_bf16_f32 v124, v160, v161
    v_cvt_pk_bf16_f32 v125, v162, v163
    v_cvt_pk_bf16_f32 v126, v164, v165
    v_cvt_pk_bf16_f32 v127, v166, v167
    v_min_u32 v124, -2, v124
    v_min_u32 v125, -2, v125
    v_min_u32 v126, -2, v126
    v_min_u32 v127, -2, v127
    buffer_store_dwordx4 v[124:127], v4, s[72:75], s19 offen offset:1024 sc1
    ds_add_u32 v1, v2 offset:60
    s_or_b32 s79, s2, s6
    s_cmp_lg_u32 s79, 0
    s_cbranch_scc1 L_A_end
    v_lshlrev_b32 v186, 9, v0
L_A_all:
    s_mov_b32 s80, 65536
    buffer_load_dwordx2 v[176:177], v186, s[72:75], s80 offen sc1
    s_mov_b32 s80, 98304
    buffer_load_dwordx2 v[178:179], v186, s[72:75], s80 offen sc1
    s_mov_b32 s80, 131072
    buffer_load_dwordx2 v[180:181], v186, s[72:75], s80 offen sc1
    s_mov_b32 s80, 163840
    buffer_load_dwordx2 v[182:183], v186, s[72:75], s80 offen sc1
    s_waitcnt vmcnt(0)
    s_mov_b64 s[12:13], 0
    v_cmp_ne_u64 vcc, s[76:77], v[176:177]
    s_or_b64 s[12:13], s[12:13], vcc
    v_cmp_ne_u64 vcc, s[76:77], v[178:179]
    s_or_b64 s[12:13], s[12:13], vcc
    v_cmp_ne_u64 vcc, s[76:77], v[180:181]
    s_or_b64 s[12:13], s[12:13], vcc
    v_cmp_ne_u64 vcc, s[76:77], v[182:183]
    s_or_b64 s[12:13], s[12:13], vcc
    s_cmp_eq_u64 s[12:13], 0
    s_cbranch_scc1 L_A_bump
    s_sub_u32 s83, s83, 1
    s_cbranch_scc0 L_A_all
L_A_bump:
    s_mov_b32 s79, 0
    s_mov_b64 exec, 1
    buffer_store_dwordx2 v[6:7], off, s[72:75], s79 sc1
    s_mov_b64 exec, -1
L_A_end:
    s_endpgm
L_A_slow:
    v_lshlrev_b32 v178, 7, v0
    s_mov_b32 s80, 4096
L_gp_153:
    buffer_load_dwordx2 v[176:177], v178, s[72:75], s80 offen sc1
    s_waitcnt vmcnt(0)
    v_cmp_ne_u64 vcc, s[76:77], v[176:177]
    s_cbranch_vccz L_gpd_154
    s_sub_u32 s83, s83, 1
    s_cbranch_scc0 L_gp_153
    s_mov_b32 s83, 0
L_gpd_154:
    s_mov_b32 s80, 12288
L_gp_155:
    buffer_load_dwordx2 v[176:177], v178, s[72:75], s80 offen sc1
    s_waitcnt vmcnt(0)
    v_cmp_ne_u64 vcc, s[76:77], v[176:177]
    s_cbranch_vccz L_gpd_156
    s_sub_u32 s83, s83, 1
    s_cbranch_scc0 L_gp_155
    s_mov_b32 s83, 0
L_gpd_156:
    s_mov_b32 s80, 20480
L_gp_157:
    buffer_load_dwordx2 v[176:177], v178, s[72:75], s80 offen sc1
    s_waitcnt vmcnt(0)
    v_cmp_ne_u64 vcc, s[76:77], v[176:177]
    s_cbranch_vccz L_gpd_158
    s_sub_u32 s83, s83, 1
    s_cbranch_scc0 L_gp_157
    s_mov_b32 s83, 0
L_gpd_158:
    s_mov_b32 s80, 28672
L_gp_159:
    buffer_load_dwordx2 v[176:177], v178, s[72:75], s80 offen sc1
    s_waitcnt vmcnt(0)
    v_cmp_ne_u64 vcc, s[76:77], v[176:177]
    s_cbranch_vccz L_gpd_160
    s_sub_u32 s83, s83, 1
    s_cbranch_scc0 L_gp_159
    s_mov_b32 s83, 0
L_gpd_160:
    v_mov_b32 v252, 0xff800000
    v_mov_b32 v253, 0xff800000
    s_mov_b32 s81, 327680
L_A_slow1:
    buffer_load_dwordx4 v[240:243], v4, s[72:75], s81 offen sc1
    s_waitcnt vmcnt(0)
    v_mfma_f32_32x32x16_bf16 v[72:87], v[240:243], v[16:19], 0
    v_mfma_f32_32x32x16_bf16 v[88:103], v[240:243], v[20:23], 0
    s_nop 11
    v_max3_f32 v252, v72, v73, v252
    v_max3_f32 v252, v74, v75, v252
    v_max3_f32 v252, v76, v77, v252
    v_max3_f32 v252, v78, v79, v252
    v_max3_f32 v252, v80, v81, v252
    v_max3_f32 v252, v82, v83, v252
    v_max3_f32 v252, v84, v85, v252
    v_max3_f32 v252, v86, v87, v252
    v_max3_f32 v253, v88, v89, v253
    v_max3_f32 v253, v90, v91, v253
    v_max3_f32 v253, v92, v93, v253
    v_max3_f32 v253, v94, v95, v253
    v_max3_f32 v253, v96, v97, v253
    v_max3_f32 v253, v98, v99, v253
    v_max3_f32 v253, v100, v101, v253
    v_max3_f32 v253, v102, v103, v253
    s_add_u32 s81, s81, 2048
    s_cmp_lt_u32 s81, 458752
    s_cbranch_scc1 L_A_slow1
    v_mov_b32 v176, v252
    s_nop 1
    v_permlane32_swap_b32 v252, v176
    v_max_f32 v252, v252, v176
    v_sub_f32 v208, 0, v252
    v_sub_f32 v209, 0, v252
    v_sub_f32 v210, 0, v252
    v_sub_f32 v211, 0, v252
    v_sub_f32 v212, 0, v252
    v_sub_f32 v213, 0, v252
    v_sub_f32 v214, 0, v252
    v_sub_f32 v215, 0, v252
    v_sub_f32 v216, 0, v252
    v_sub_f32 v217, 0, v252
    v_sub_f32 v218, 0, v252
    v_sub_f32 v219, 0, v252
    v_sub_f32 v220, 0, v252
    v_sub_f32 v221, 0, v252
    v_sub_f32 v222, 0, v252
    v_sub_f32 v223, 0, v252
    v_mov_b32 v176, v253
    s_nop 1
    v_permlane32_swap_b32 v253, v176
    v_max_f32 v253, v253, v176
    v_sub_f32 v224, 0, v253
    v_sub_f32 v225, 0, v253
    v_sub_f32 v226, 0, v253
    v_sub_f32 v227, 0, v253
    v_sub_f32 v228, 0, v253
    v_sub_f32 v229, 0, v253
    v_sub_f32 v230, 0, v253
    v_sub_f32 v231, 0, v253
    v_sub_f32 v232, 0, v253
    v_sub_f32 v233, 0, v253
    v_sub_f32 v234, 0, v253
    v_sub_f32 v235, 0, v253
    v_sub_f32 v236, 0, v253
    v_sub_f32 v237, 0, v253
    v_sub_f32 v238, 0, v253
    v_sub_f32 v239, 0, v253
    v_mov_b32 v144, 0
    v_mov_b32 v160, 0
    v_mov_b32 v145, 0
    v_mov_b32 v161, 0
    v_mov_b32 v146, 0
    v_mov_b32 v162, 0
    v_mov_b32 v147, 0
    v_mov_b32 v163, 0
    v_mov_b32 v148, 0
    v_mov_b32 v164, 0
    v_mov_b32 v149, 0
    v_mov_b32 v165, 0
    v_mov_b32 v150, 0
    v_mov_b32 v166, 0
    v_mov_b32 v151, 0
    v_mov_b32 v167, 0
    v_mov_b32 v152, 0
    v_mov_b32 v168, 0
    v_mov_b32 v153, 0
    v_mov_b32 v169, 0
    v_mov_b32 v154, 0
    v_mov_b32 v170, 0
    v_mov_b32 v155, 0
    v_mov_b32 v171, 0
    v_mov_b32 v156, 0
    v_mov_b32 v172, 0
    v_mov_b32 v157, 0
    v_mov_b32 v173, 0
    v_mov_b32 v158, 0
    v_mov_b32 v174, 0
    v_mov_b32 v159, 0
    v_mov_b32 v175, 0
    v_mov_b32 v244, 0x3f803f80
    v_mov_b32 v245, 0x3f803f80
    v_mov_b32 v246, 0x3f803f80
    v_mov_b32 v247, 0x3f803f80
    v_mov_b32 v248, 0x3f803f80
    v_mov_b32 v249, 0x3f803f80
    v_mov_b32 v250, 0x3f803f80
    v_mov_b32 v251, 0x3f803f80
    v_and_b32 v254, 15, v0
    v_lshrrev_b32 v176, 5, v0
    v_lshl_add_u32 v254, v176, 4, v254
    v_lshlrev_b32 v254, 4, v254
    s_mov_b32 s81, 327680
L_A_slow2:
    buffer_load_dwordx4 v[240:243], v4, s[72:75], s81 offen sc1
    s_mov_b32 exec_lo, 0x0000ffff
    s_mov_b32 exec_hi, 0x0000ffff
    buffer_load_dwordx4 v[244:247], v254, s[72:75], s81 offen offset:1024 sc1
    buffer_load_dwordx4 v[248:251], v254, s[72:75], s81 offen offset:1536 sc1
    s_mov_b64 exec, -1
    s_waitcnt vmcnt(0)
    v_mfma_f32_32x32x16_bf16 v[72:87], v[240:243], v[16:19], v[208:223]
    v_mfma_f32_32x32x16_bf16 v[88:103], v[240:243], v[20:23], v[224:239]
    s_nop 11
    v_exp_f32 v72, v72
    v_exp_f32 v73, v73
    v_exp_f32 v74, v74
    v_exp_f32 v75, v75
    v_exp_f32 v76, v76
    v_exp_f32 v77, v77
    v_exp_f32 v78, v78
    v_exp_f32 v79, v79
    v_exp_f32 v80, v80
    v_exp_f32 v81, v81
    v_exp_f32 v82, v82
    v_exp_f32 v83, v83
    v_exp_f32 v84, v84
    v_exp_f32 v85, v85
    v_exp_f32 v86, v86
    v_exp_f32 v87, v87
    v_exp_f32 v88, v88
    v_exp_f32 v89, v89
    v_exp_f32 v90, v90
    v_exp_f32 v91, v91
    v_exp_f32 v92, v92
    v_exp_f32 v93, v93
    v_exp_f32 v94, v94
    v_exp_f32 v95, v95
    v_exp_f32 v96, v96
    v_exp_f32 v97, v97
    v_exp_f32 v98, v98
    v_exp_f32 v99, v99
    v_exp_f32 v100, v100
    v_exp_f32 v101, v101
    v_exp_f32 v102, v102
    v_exp_f32 v103, v103
    s_nop 1
    v_smfmac_f32_32x32x32_bf16 v[144:159], v[244:247], v[72:79], v112
    v_smfmac_f32_32x32x32_bf16 v[144:159], v[248:251], v[80:87], v112
    v_smfmac_f32_32x32x32_bf16 v[160:175], v[244:247], v[88:95], v112
    v_smfmac_f32_32x32x32_bf16 v[160:175], v[248:251], v[96:103], v112
    s_add_u32 s81, s81, 2048
    s_cmp_lt_u32 s81, 458752
    s_cbranch_scc1 L_A_slow2
    s_nop 11
    s_cmp_eq_u32 s15, 0
    s_cbranch_scc1 L_A_slow3
    v_rcp_f32 v122, v152
    s_nop 0
    v_mul_f32 v122, v122, v137
    v_pk_mul_f32 v[144:145], v[144:145], v[122:123] op_sel_hi:[1,0]
    v_pk_mul_f32 v[146:147], v[146:147], v[122:123] op_sel_hi:[1,0]
    v_pk_mul_f32 v[148:149], v[148:149], v[122:123] op_sel_hi:[1,0]
    v_pk_mul_f32 v[150:151], v[150:151], v[122:123] op_sel_hi:[1,0]
    v_cvt_pk_bf16_f32 v124, v144, v145
    v_cvt_pk_bf16_f32 v125, v146, v147
    v_cvt_pk_bf16_f32 v126, v148, v149
    v_cvt_pk_bf16_f32 v127, v150, v151
    v_min_u32 v124, -2, v124
    v_min_u32 v125, -2, v125
    v_min_u32 v126, -2, v126
    v_min_u32 v127, -2, v127
    buffer_store_dwordx4 v[124:127], v4, s[72:75], s19 offen sc1
    s_nop 1
L_A_slow3:
    v_rcp_f32 v122, v168
    s_nop 0
    v_mul_f32 v122, v122, v137
    s_branch L_A_fin
L_spin_2:
    s_sleep 1
    ds_read_b32 v3, v5 offset:24
    s_waitcnt lgkmcnt(0)
    v_readfirstlane_b32 s84, v3
    s_cmp_ge_u32 s84, 1
    s_cbranch_scc1 L_ok_1
    s_sub_u32 s83, s83, 1
    s_cbranch_scc0 L_spin_2
    s_mov_b32 s83, 0
    s_branch L_ok_1
L_spin_4:
    s_sleep 1
    ds_read_b32 v3, v1 offset:0
    s_waitcnt lgkmcnt(0)
    v_readfirstlane_b32 s84, v3
    s_cmp_ge_u32 s84, 4
    s_cbranch_scc1 L_ok_3
    s_sub_u32 s83, s83, 1
    s_cbranch_scc0 L_spin_4
    s_mov_b32 s83, 0
    s_branch L_ok_3
L_spin_6:
    s_sleep 1
    ds_read_b32 v3, v5 offset:24
    s_waitcnt lgkmcnt(0)
    v_readfirstlane_b32 s84, v3
    s_cmp_ge_u32 s84, 2
    s_cbranch_scc1 L_ok_5
    s_sub_u32 s83, s83, 1
    s_cbranch_scc0 L_spin_6
    s_mov_b32 s83, 0
    s_branch L_ok_5
L_spin_8:
    s_sleep 1
    ds_read_b32 v3, v1 offset:4
    s_waitcnt lgkmcnt(0)
    v_readfirstlane_b32 s84, v3
    s_cmp_ge_u32 s84, 4
    s_cbranch_scc1 L_ok_7
    s_sub_u32 s83, s83, 1
    s_cbranch_scc0 L_spin_8
    s_mov_b32 s83, 0
    s_branch L_ok_7
L_spin_10:
    s_sleep 1
    ds_read_b32 v3, v5 offset:24
    s_waitcnt lgkmcnt(0)
    v_readfirstlane_b32 s84, v3
    s_cmp_ge_u32 s84, 3
    s_cbranch_scc1 L_ok_9
    s_sub_u32 s83, s83, 1
    s_cbranch_scc0 L_spin_10
    s_mov_b32 s83, 0
    s_branch L_ok_9
L_spin_12:
    s_sleep 1
    ds_read_b32 v3, v5 offset:24
    s_waitcnt lgkmcnt(0)
    v_readfirstlane_b32 s84, v3
    s_cmp_ge_u32 s84, 4
    s_cbranch_scc1 L_ok_11
    s_sub_u32 s83, s83, 1
    s_cbranch_scc0 L_spin_12
    s_mov_b32 s83, 0
    s_branch L_ok_11
L_spin_14:
    s_sleep 1
    ds_read_b32 v3, v1 offset:100
    s_waitcnt lgkmcnt(0)
    s_setprio 2
    v_readfirstlane_b32 s84, v3
    s_setprio 0
    s_cmp_ge_u32 s84, 4
    s_cbranch_scc1 L_ok_13
    s_sub_u32 s83, s83, 1
    s_cbranch_scc0 L_spin_14
    s_mov_b32 s83, 0
    s_branch L_ok_13
L_spin_16:
    s_sleep 1
    ds_read_b32 v3, v1 offset:16
    s_waitcnt lgkmcnt(0)
    s_setprio 2
    v_readfirstlane_b32 s84, v3
    s_setprio 0
    s_cmp_ge_u32 s84, 4
    s_cbranch_scc1 L_ok_15
    s_sub_u32 s83, s83, 1
    s_cbranch_scc0 L_spin_16
    s_mov_b32 s83, 0
    s_branch L_ok_15
L_spin_24:
    s_sleep 1
    ds_read_b32 v3, v1 offset:20
    s_waitcnt lgkmcnt(0)
    s_setprio 2
    v_readfirstlane_b32 s84, v3
    s_setprio 0
    s_cmp_ge_u32 s84, 4
    s_cbranch_scc1 L_ok_23
    s_sub_u32 s83, s83, 1
    s_cbranch_scc0 L_spin_24
    s_mov_b32 s83, 0
    s_branch L_ok_23
L_spin_34:
    s_sleep 1
    ds_read_b32 v3, v1 offset:24
    s_waitcnt lgkmcnt(0)
    s_setprio 2
    v_readfirstlane_b32 s84, v3
    s_setprio 0
    s_cmp_ge_u32 s84, 4
    s_cbranch_scc1 L_ok_33
    s_sub_u32 s83, s83, 1
    s_cbranch_scc0 L_spin_34
    s_mov_b32 s83, 0
    s_branch L_ok_33
L_spin_44:
    s_sleep 1
    ds_read_b32 v3, v1 offset:28
    s_waitcnt lgkmcnt(0)
    s_setprio 2
    v_readfirstlane_b32 s84, v3
    s_setprio 0
    s_cmp_ge_u32 s84, 4
    s_cbranch_scc1 L_ok_43
    s_sub_u32 s83, s83, 1
    s_cbranch_scc0 L_spin_44
    s_mov_b32 s83, 0
    s_branch L_ok_43
L_spin_50:
    s_sleep 1
    ds_read_b32 v3, v1 offset:124
    s_waitcnt lgkmcnt(0)
    s_setprio 2
    v_readfirstlane_b32 s84, v3
    s_setprio 0
    s_cmp_ge_u32 s84, 4
    s_cbranch_scc1 L_ok_49
    s_sub_u32 s83, s83, 1
    s_cbranch_scc0 L_spin_50
    s_mov_b32 s83, 0
    s_branch L_ok_49
L_spin_56:
    s_sleep 1
    ds_read_b32 v3, v1 offset:32
    s_waitcnt lgkmcnt(0)
    s_setprio 2
    v_readfirstlane_b32 s84, v3
    s_setprio 0
    s_cmp_ge_u32 s84, 4
    s_cbranch_scc1 L_ok_55
    s_sub_u32 s83, s83, 1
    s_cbranch_scc0 L_spin_56
    s_mov_b32 s83, 0
    s_branch L_ok_55
L_spin_66:
    s_sleep 1
    ds_read_b32 v3, v1 offset:36
    s_waitcnt lgkmcnt(0)
    s_setprio 2
    v_readfirstlane_b32 s84, v3
    s_setprio 0
    s_cmp_ge_u32 s84, 4
    s_cbranch_scc1 L_ok_65
    s_sub_u32 s83, s83, 1
    s_cbranch_scc0 L_spin_66
    s_mov_b32 s83, 0
    s_branch L_ok_65
L_spin_76:
    s_sleep 1
    ds_read_b32 v3, v1 offset:40
    s_waitcnt lgkmcnt(0)
    s_setprio 2
    v_readfirstlane_b32 s84, v3
    s_setprio 0
    s_cmp_ge_u32 s84, 4
    s_cbranch_scc1 L_ok_75
    s_sub_u32 s83, s83, 1
    s_cbranch_scc0 L_spin_76
    s_mov_b32 s83, 0
    s_branch L_ok_75
L_spin_86:
    s_sleep 1
    ds_read_b32 v3, v1 offset:44
    s_waitcnt lgkmcnt(0)
    s_setprio 2
    v_readfirstlane_b32 s84, v3
    s_setprio 0
    s_cmp_ge_u32 s84, 4
    s_cbranch_scc1 L_ok_85
    s_sub_u32 s83, s83, 1
    s_cbranch_scc0 L_spin_86
    s_mov_b32 s83, 0
    s_branch L_ok_85
L_spin_98:
    s_sleep 1
    ds_read_b32 v3, v1 offset:48
    s_waitcnt lgkmcnt(0)
    s_setprio 2
    v_readfirstlane_b32 s84, v3
    s_setprio 0
    s_cmp_ge_u32 s84, 4
    s_cbranch_scc1 L_ok_97
    s_sub_u32 s83, s83, 1
    s_cbranch_scc0 L_spin_98
    s_mov_b32 s83, 0
    s_branch L_ok_97
L_G_await:
    s_setprio 0
    ds_read_b32 v3, v1 offset:96
    s_waitcnt lgkmcnt(0)
    s_setprio 2
    v_readfirstlane_b32 s84, v3
    s_setprio 0
    s_cmp_ge_u32 s84, 4
    s_cbranch_scc0 L_spin_91002
L_ok_91001:
    ds_read_b32 v3, v1 offset:60
    s_waitcnt lgkmcnt(0)
    s_setprio 2
    v_readfirstlane_b32 s84, v3
    s_setprio 0
    s_cmp_ge_u32 s84, 4
    s_cbranch_scc0 L_spin_91004
L_ok_91003:
    s_setprio 2
    s_branch L_G_aback
L_spin_91002:
    s_sleep 10
    ds_read_b32 v3, v1 offset:96
    s_waitcnt lgkmcnt(0)
    s_setprio 2
    v_readfirstlane_b32 s84, v3
    s_setprio 0
    s_cmp_ge_u32 s84, 4
    s_cbranch_scc1 L_ok_91001
    s_sub_u32 s83, s83, 1
    s_cbranch_scc0 L_spin_91002
    s_mov_b32 s83, 0
    s_branch L_ok_91001
L_spin_91004:
    s_sleep 3
    ds_read_b32 v3, v1 offset:60
    s_waitcnt lgkmcnt(0)
    s_setprio 2
    v_readfirstlane_b32 s84, v3
    s_setprio 0
    s_cmp_ge_u32 s84, 4
    s_cbranch_scc1 L_ok_91003
    s_sub_u32 s83, s83, 1
    s_cbranch_scc0 L_spin_91004
    s_mov_b32 s83, 0
    s_branch L_ok_91003
L_ort_101:
    buffer_load_dwordx4 v[192:195], v4, s[72:75], s8 offen sc1
    s_add_u32 s81, s8, s29
    buffer_load_dwordx4 v[196:199], v4, s[72:75], s81 offen sc1
    buffer_load_dwordx4 v[200:203], v4, s[72:75], s9 offen sc1
    s_add_u32 s81, s9, s29
    buffer_load_dwordx4 v[204:207], v4, s[72:75], s81 offen sc1
    buffer_load_dwordx4 v[208:211], v4, s[72:75], s10 offen sc1
    s_add_u32 s81, s10, s29
    buffer_load_dwordx4 v[212:215], v4, s[72:75], s81 offen sc1
    buffer_load_dwordx4 v[216:219], v4, s[72:75], s11 offen sc1
    s_add_u32 s81, s11, s29
    buffer_load_dwordx4 v[220:223], v4, s[72:75], s81 offen sc1
    s_waitcnt vmcnt(0)
    v_max3_u32 v3, v192, v193, v194
    v_max3_u32 v3, v195, v196, v3
    v_max3_u32 v3, v197, v198, v3
    v_max_u32 v3, v199, v3
    v_cmp_eq_u32 vcc, -1, v3
    s_cbranch_vccz L_ook_102
    s_sub_u32 s83, s83, 1
    s_cbranch_scc0 L_ort_101
    s_mov_b32 s83, 0
    s_branch L_ook_102
L_ort_103:
    buffer_load_dwordx4 v[200:203], v4, s[72:75], s9 offen sc1
    s_add_u32 s81, s9, s29
    buffer_load_dwordx4 v[204:207], v4, s[72:75], s81 offen sc1
    buffer_load_dwordx4 v[208:211], v4, s[72:75], s10 offen sc1
    s_add_u32 s81, s10, s29
    buffer_load_dwordx4 v[212:215], v4, s[72:75], s81 offen sc1
    buffer_load_dwordx4 v[216:219], v4, s[72:75], s11 offen sc1
    s_add_u32 s81, s11, s29
    buffer_load_dwordx4 v[220:223], v4, s[72:75], s81 offen sc1
    s_waitcnt vmcnt(0)
    v_max3_u32 v3, v200, v201, v202
    v_max3_u32 v3, v203, v204, v3
    v_max3_u32 v3, v205, v206, v3
    v_max_u32 v3, v207, v3
    v_cmp_eq_u32 vcc, -1, v3
    s_cbranch_vccz L_ook_104
    s_sub_u32 s83, s83, 1
    s_cbranch_scc0 L_ort_103
    s_mov_b32 s83, 0
    s_branch L_ook_104
L_ort_105:
    buffer_load_dwordx4 v[208:211], v4, s[72:75], s10 offen sc1
    s_add_u32 s81, s10, s29
    buffer_load_dwordx4 v[212:215], v4, s[72:75], s81 offen sc1
    buffer_load_dwordx4 v[216:219], v4, s[72:75], s11 offen sc1
    s_add_u32 s81, s11, s29
    buffer_load_dwordx4 v[220:223], v4, s[72:75], s81 offen sc1
    s_waitcnt vmcnt(0)
    v_max3_u32 v3, v208, v209, v210
    v_max3_u32 v3, v211, v212, v3
    v_max3_u32 v3, v213, v214, v3
    v_max_u32 v3, v215, v3
    v_cmp_eq_u32 vcc, -1, v3
    s_cbranch_vccz L_ook_106
    s_sub_u32 s83, s83, 1
    s_cbranch_scc0 L_ort_105
    s_mov_b32 s83, 0
    s_branch L_ook_106
L_ort_107:
    buffer_load_dwordx4 v[216:219], v4, s[72:75], s11 offen sc1
    s_add_u32 s81, s11, s29
    buffer_load_dwordx4 v[220:223], v4, s[72:75], s81 offen sc1
    s_waitcnt vmcnt(0)
    v_max3_u32 v3, v216, v217, v218
    v_max3_u32 v3, v219, v220, v3
    v_max3_u32 v3, v221, v222, v3
    v_max_u32 v3, v223, v3
    v_cmp_eq_u32 vcc, -1, v3
    s_cbranch_vccz L_ook_108
    s_sub_u32 s83, s83, 1
    s_cbranch_scc0 L_ort_107
    s_mov_b32 s83, 0
    s_branch L_ook_108
L_ort_109:
    buffer_load_dwordx4 v[224:227], v4, s[72:75], s12 offen sc1
    s_add_u32 s81, s12, s29
    buffer_load_dwordx4 v[228:231], v4, s[72:75], s81 offen sc1
    buffer_load_dwordx4 v[232:235], v4, s[72:75], s13 offen sc1
    s_add_u32 s81, s13, s29
    buffer_load_dwordx4 v[236:239], v4, s[72:75], s81 offen sc1
    buffer_load_dwordx4 v[240:243], v4, s[72:75], s14 offen sc1
    s_add_u32 s81, s14, s29
    buffer_load_dwordx4 v[244:247], v4, s[72:75], s81 offen sc1
    buffer_load_dwordx4 v[248:251], v4, s[72:75], s15 offen sc1
    s_add_u32 s81, s15, s29
    buffer_load_dwordx4 v[252:255], v4, s[72:75], s81 offen sc1
    s_waitcnt vmcnt(6)
    v_max3_u32 v3, v224, v225, v226
    v_max3_u32 v3, v227, v228, v3
    v_max3_u32 v3, v229, v230, v3
    v_max_u32 v3, v231, v3
    v_cmp_eq_u32 vcc, -1, v3
    s_cbranch_vccz L_ook_110
    s_sub_u32 s83, s83, 1
    s_cbranch_scc0 L_ort_109
    s_mov_b32 s83, 0
    s_branch L_ook_110
L_ort_111:
    buffer_load_dwordx4 v[232:235], v4, s[72:75], s13 offen sc1
    s_add_u32 s81, s13, s29
    buffer_load_dwordx4 v[236:239], v4, s[72:75], s81 offen sc1
    buffer_load_dwordx4 v[240:243], v4, s[72:75], s14 offen sc1
    s_add_u32 s81, s14, s29
    buffer_load_dwordx4 v[244:247], v4, s[72:75], s81 offen sc1
    buffer_load_dwordx4 v[248:251], v4, s[72:75], s15 offen sc1
    s_add_u32 s81, s15, s29
    buffer_load_dwordx4 v[252:255], v4, s[72:75], s81 offen sc1
    s_waitcnt vmcnt(4)
    v_max3_u32 v3, v232, v233, v234
    v_max3_u32 v3, v235, v236, v3
    v_max3_u32 v3, v237, v238, v3
    v_max_u32 v3, v239, v3
    v_cmp_eq_u32 vcc, -1, v3
    s_cbranch_vccz L_ook_112
    s_sub_u32 s83, s83, 1
    s_cbranch_scc0 L_ort_111
    s_mov_b32 s83, 0
    s_branch L_ook_112
L_ort_113:
    buffer_load_dwordx4 v[240:243], v4, s[72:75], s14 offen sc1
    s_add_u32 s81, s14, s29
    buffer_load_dwordx4 v[244:247], v4, s[72:75], s81 offen sc1
    buffer_load_dwordx4 v[248:251], v4, s[72:75], s15 offen sc1
    s_add_u32 s81, s15, s29
    buffer_load_dwordx4 v[252:255], v4, s[72:75], s81 offen sc1
    s_waitcnt vmcnt(2)
    v_max3_u32 v3, v240, v241, v242
    v_max3_u32 v3, v243, v244, v3
    v_max3_u32 v3, v245, v246, v3
    v_max_u32 v3, v247, v3
    v_cmp_eq_u32 vcc, -1, v3
    s_cbranch_vccz L_ook_114
    s_sub_u32 s83, s83, 1
    s_cbranch_scc0 L_ort_113
    s_mov_b32 s83, 0
    s_branch L_ook_114
L_ort_115:
    buffer_load_dwordx4 v[248:251], v4, s[72:75], s15 offen sc1
    s_add_u32 s81, s15, s29
    buffer_load_dwordx4 v[252:255], v4, s[72:75], s81 offen sc1
    s_waitcnt vmcnt(0)
    v_max3_u32 v3, v248, v249, v250
    v_max3_u32 v3, v251, v252, v3
    v_max3_u32 v3, v253, v254, v3
    v_max_u32 v3, v255, v3
    v_cmp_eq_u32 vcc, -1, v3
    s_cbranch_vccz L_ook_116
    s_sub_u32 s83, s83, 1
    s_cbranch_scc0 L_ort_115
    s_mov_b32 s83, 0
    s_branch L_ook_116
L_spin_118:
    s_sleep 1
    ds_read_b32 v3, v1 offset:12
    s_waitcnt lgkmcnt(0)
    v_readfirstlane_b32 s84, v3
    s_cmp_ge_u32 s84, 4
    s_cbranch_scc1 L_ok_117
    s_sub_u32 s83, s83, 1
    s_cbranch_scc0 L_spin_118
    s_mov_b32 s83, 0
    s_branch L_ok_117
L_spin_122:
    s_sleep 1
    ds_read_b32 v3, v5 offset:0
    s_waitcnt lgkmcnt(0)
    v_readfirstlane_b32 s84, v3
    s_cmp_ge_u32 s84, 1
    s_cbranch_scc1 L_ok_121
    s_sub_u32 s83, s83, 1
    s_cbranch_scc0 L_spin_122
    s_mov_b32 s83, 0
    s_branch L_ok_121
L_spin_132:
    s_sleep 1
    ds_read_b32 v3, v1 offset:120
    s_waitcnt lgkmcnt(0)
    v_readfirstlane_b32 s84, v3
    s_cmp_ge_u32 s84, 1
    s_cbranch_scc1 L_ok_131
    s_sub_u32 s83, s83, 1
    s_cbranch_scc0 L_spin_132
    s_mov_b32 s83, 0
    s_branch L_ok_131
L_spin_136:
    s_sleep 1
    ds_read_b32 v3, v1 offset:64
    s_waitcnt lgkmcnt(0)
    v_readfirstlane_b32 s84, v3
    s_cmp_ge_u32 s84, 4
    s_cbranch_scc1 L_ok_135
    s_sub_u32 s83, s83, 1
    s_cbranch_scc0 L_spin_136
    s_mov_b32 s83, 0
    s_branch L_ok_135
L_spin_138:
    ds_read_b32 v3, v5 offset:0
    s_waitcnt lgkmcnt(0)
    v_readfirstlane_b32 s84, v3
    s_cmp_ge_u32 s84, 2
    s_cbranch_scc1 L_ok_137
    s_sub_u32 s83, s83, 1
    s_cbranch_scc0 L_spin_138
    s_mov_b32 s83, 0
    s_branch L_ok_137
L_A_first:
    ds_read_b32 v3, v1 offset:8
    s_waitcnt lgkmcnt(0)
    v_readfirstlane_b32 s84, v3
    s_cmp_ge_u32 s84, 4
    s_cbranch_scc0 L_spin_90002
L_ok_90001:
    s_mov_b32 m0, s10
    s_add_u32 s81, s86, 8192
    buffer_load_dwordx4 v4, s[44:47], s86 offen sc1 lds
    buffer_load_dwordx4 v4, s[44:47], s86 offen offset:1024 sc1 lds
    buffer_load_dwordx2 v[192:193], v179, s[72:75], s18 offen sc1
    buffer_load_dwordx2 v[194:195], v189, s[72:75], s30 offen sc1
    s_mov_b32 m0, s11
    s_and_b32 s81, s81, 0x1ffff
    buffer_load_dwordx4 v4, s[44:47], s81 offen sc1 lds
    buffer_load_dwordx4 v4, s[44:47], s81 offen offset:1024 sc1 lds
    s_mov_b64 exec, 3
    v_add_u32 v178, s10, v4
    ds_write_b128 v178, v[180:183] offset:2048
    v_add_u32 v178, s11, v4
    ds_write_b128 v178, v[180:183] offset:2048
    s_mov_b64 exec, -1
    ds_add_u32 v1, v2 offset:100
    s_branch L_A_s0
L_spin_90002:
    s_sleep 1
    ds_read_b32 v3, v1 offset:8
    s_waitcnt lgkmcnt(0)
    v_readfirstlane_b32 s84, v3
    s_cmp_ge_u32 s84, 4
    s_cbranch_scc1 L_ok_90001
    s_sub_u32 s83, s83, 1
    s_cbranch_scc0 L_spin_90002
    s_mov_b32 s83, 0
    s_branch L_ok_90001
L_spin_140:
    ds_read_b32 v3, v1 offset:68
    s_waitcnt lgkmcnt(0)
    v_readfirstlane_b32 s84, v3
    s_cmp_ge_u32 s84, s85
    s_cbranch_scc1 L_ok_139
    s_sub_u32 s83, s83, 1
    s_cbranch_scc0 L_spin_140
    s_mov_b32 s83, 0
    s_branch L_ok_139
L_A_fchk:
    v_cmp_ne_u64 s[12:13], s[76:77], v[192:193]
    v_cmp_ne_u64 vcc, s[76:77], v[194:195]
    s_or_b64 vcc, vcc, s[12:13]
    s_cbranch_vccz L_A_fok
L_A_frl:
    buffer_load_dwordx2 v[192:193], v179, s[72:75], s18 offen sc1
    buffer_load_dwordx2 v[194:195], v189, s[72:75], s30 offen sc1
    s_waitcnt vmcnt(0)
    v_cmp_ne_u64 s[12:13], s[76:77], v[192:193]
    v_cmp_ne_u64 vcc, s[76:77], v[194:195]
    s_or_b64 vcc, vcc, s[12:13]
    s_cbranch_vccz L_A_fok
    s_sub_u32 s83, s83, 1
    s_cbranch_scc0 L_A_frl
    s_mov_b32 s83, 0
    s_mov_b64 vcc, 0
L_A_fok:
    ds_add_u32 v1, v2 offset:124
    s_branch L_A_fbk
L_spin_142:
    ds_read_b32 v3, v1 offset:72
    s_waitcnt lgkmcnt(0)
    v_readfirstlane_b32 s84, v3
    s_cmp_ge_u32 s84, s85
    s_cbranch_scc1 L_ok_141
    s_sub_u32 s83, s83, 1
    s_cbranch_scc0 L_spin_142
    s_mov_b32 s83, 0
    s_branch L_ok_141
L_spin_144:
    ds_read_b32 v3, v1 offset:76
    s_waitcnt lgkmcnt(0)
    v_readfirstlane_b32 s84, v3
    s_cmp_ge_u32 s84, s85
    s_cbranch_scc1 L_ok_143
    s_sub_u32 s83, s83, 1
    s_cbranch_scc0 L_spin_144
    s_mov_b32 s83, 0
    s_branch L_ok_143
L_spin_146:
    ds_read_b32 v3, v1 offset:64
    s_waitcnt lgkmcnt(0)
    v_readfirstlane_b32 s84, v3
    s_cmp_ge_u32 s84, s85
    s_cbranch_scc1 L_ok_145
    s_sub_u32 s83, s83, 1
    s_cbranch_scc0 L_spin_146
    s_mov_b32 s83, 0
    s_branch L_ok_145
L_spin_148:
    ds_read_b32 v3, v1 offset:68
    s_waitcnt lgkmcnt(0)
    v_readfirstlane_b32 s84, v3
    s_cmp_ge_u32 s84, s85
    s_cbranch_scc1 L_ok_147
    s_sub_u32 s83, s83, 1
    s_cbranch_scc0 L_spin_148
    s_mov_b32 s83, 0
    s_branch L_ok_147
L_spin_150:
    ds_read_b32 v3, v1 offset:72
    s_waitcnt lgkmcnt(0)
    v_readfirstlane_b32 s84, v3
    s_cmp_ge_u32 s84, s85
    s_cbranch_scc1 L_ok_149
    s_sub_u32 s83, s83, 1
    s_cbranch_scc0 L_spin_150
    s_mov_b32 s83, 0
    s_branch L_ok_149
L_spin_152:
    ds_read_b32 v3, v1 offset:68
    s_waitcnt lgkmcnt(0)
    v_readfirstlane_b32 s84, v3
    s_cmp_ge_u32 s84, s85
    s_cbranch_scc1 L_ok_151
    s_sub_u32 s83, s83, 1
    s_cbranch_scc0 L_spin_152
    s_mov_b32 s83, 0
    s_branch L_ok_151
L_A_abad:
    s_mov_b32 s15, 1
    s_branch L_A_aback
L_exit:
    s_endpgm
.section .rodata,"a"
.p2align 6
.amdhsa_kernel gated_mix__grouped_kv_mqa__glu_gated_geglu__prompt_kernel
  .amdhsa_next_free_vgpr 256
  .amdhsa_next_free_sgpr 102
  .amdhsa_accum_offset 256
  .amdhsa_group_segment_fixed_size 0
  .amdhsa_kernarg_size 104
  .amdhsa_user_sgpr_count 2
  .amdhsa_user_sgpr_kernarg_segment_ptr 1
  .amdhsa_system_sgpr_workgroup_id_x 1
.end_amdhsa_kernel
```
